```python
import torch

def _softmax(x, axis=-1):
    return torch.softmax(x, dim=axis)
def _gelu(x):
    return torch.nn.functional.gelu(x, approximate="tanh")
def _silu(x):
    return torch.nn.functional.silu(x)
def _sigmoid(x):
    return torch.sigmoid(x)
def _layernorm(x, axis=-1, eps=1e-5):
    m = x.mean(dim=axis, keepdim=True)
    v = x.var(dim=axis, keepdim=True, unbiased=False)
    return (x - m) / torch.sqrt(v + eps)
def _scatter_add(tgt, idx, src, axis=0):
    return tgt.clone().index_add_(axis, idx, src)
def _segment_sum(src, seg, n):
    out = torch.zeros((n,) + src.shape[1:], dtype=src.dtype)
    return out.index_add_(0, seg, src)
def _pad(x, pw):
    flat = tuple(v for pair in reversed(pw) for v in pair)
    return torch.nn.functional.pad(x, flat)

kernel_name = 'sequential_preLN__sliding_block__mixer_channel_mlp__prompt'

def setup_inputs():

    _w = (lambda a: (lambda t: t.to(torch.bfloat16) if t.is_floating_point() else t)(torch.as_tensor(a)))
    def _A_setup():
        B, S, D = 1, 2048, 512
        return {
            "x": _w((lambda *s: torch.randn(*s, dtype=torch.bfloat16) * 0.05)(B, S, D)),
            "wqkv": _w((lambda *s: torch.randn(*s, dtype=torch.bfloat16) * 0.05)(D, 3 * D)),
            "wo": _w((lambda *s: torch.randn(*s, dtype=torch.bfloat16) * 0.05)(D, D)),
        }
    _A_in = _A_setup()

    def _B_setup():
        B, S, D, F = 1, 2048, 512, 1376
        return {
            "x": _w((lambda *s: torch.randn(*s, dtype=torch.bfloat16) * 0.05)(B, S, D)),
            "w1": _w((lambda *s: torch.randn(*s, dtype=torch.bfloat16) * 3.2)(D, F) * (D ** -0.5)),
            "b1": _w((lambda *s: torch.randn(*s, dtype=torch.bfloat16) * 1.6)(F)),
            "w2": _w((lambda *s: torch.randn(*s, dtype=torch.bfloat16) * 0.2)(F, D) * (F ** -0.5)),
            "b2": _w((lambda *s: torch.randn(*s, dtype=torch.bfloat16) * 0.2)(D)),
        }
    _B_in = _B_setup()

    return {
        "A_x": _A_in["x"],
        "A_wqkv": _A_in["wqkv"],
        "A_wo": _A_in["wo"],
        "B_x": _B_in["x"],
        "B_w1": _B_in["w1"],
        "B_b1": _B_in["b1"],
        "B_w2": _B_in["w2"],
        "B_b2": _B_in["b2"],
    }

def reference(A_x, A_wqkv, A_wo, B_x, B_w1, B_b1, B_w2, B_b2):
    def _A_ref(x, wqkv, wo):
        B, S, D = x.shape
        H = 32; Dh = D // H; W = 256
        qkv = (lambda x, *d: x.permute(*d))((x @ wqkv).reshape(B, S, 3, H, Dh), 2, 0, 3, 1, 4)
        q, k, v = qkv[0], qkv[1], qkv[2]
        scores = torch.einsum("bhqd,bhkd->bhqk", q, k) * (Dh ** -0.5)
        idx = torch.arange(S)
        mask = (idx[:, None] - idx[None, :] >= 0) & (idx[:, None] - idx[None, :] < W)
        scores = torch.where(mask[None, None], scores, -1e9)
        p = _softmax(scores, axis=-1)
        o = torch.einsum("bhqk,bhkd->bhqd", p, v)
        return (lambda x, *d: x.permute(*d))(o, 0, 2, 1, 3).reshape(B, S, D) @ wo

    def _B_ref(x, w1, b1, w2, b2):
        y = _layernorm(x, axis=-1)
        h = _gelu(torch.einsum("bsd,df->bsf", y, w1) + b1)
        return torch.einsum("bsf,fd->bsd", h, w2) + b2

    x = A_x
    h = x + _A_ref(_layernorm(x, axis=-1), A_wqkv, A_wo)
    h2 = h + _B_ref(_layernorm(h, axis=-1), B_w1, B_b1, B_w2, B_b2)
    return h2
```

```asm
; @launch grid=(256,1,1) block=(512,1,1) lds=163840
.amdgcn_target "amdgcn-amd-amdhsa--gfx950"
.text
.globl sequential_preLN__sliding_block__mixer_channel_mlp__prompt_kernel
.p2align 12
.p2align 8
.type sequential_preLN__sliding_block__mixer_channel_mlp__prompt_kernel,@function
sequential_preLN__sliding_block__mixer_channel_mlp__prompt_kernel:
    s_load_dwordx2 s[4:5], s[0:1], 0
    s_load_dwordx2 s[8:9], s[0:1], 8
    s_cmpk_ge_u32 s2, 0x100
    s_cbranch_scc1 L_exit
    s_bfe_u32 s45, s2, 0x30003
    s_getpc_b64 s[60:61]
L_pc:
    s_mov_b32 s62, L_end-L_pc
    s_mov_b32 s63, 0x20000
    s_lshl_b32 s52, s45, 7
    v_lshlrev_b32 v1, 7, v0
    s_mov_b32 exec_lo, 0x01010101
    s_mov_b32 exec_hi, exec_lo
    buffer_load_dword v255, v1, s[60:63], s52 offen
    s_mov_b64 exec, -1
    v_readfirstlane_b32 s52, v0
    v_and_b32 v0, 63, v0
    s_lshr_b32 s53, s2, 6
    s_and_b32 s54, s2, 7
    s_lshl2_add_u32 s44, s54, s53
    s_lshl2_add_u32 s47, s53, s54
    s_bfe_u32 s46, s52, 0x20006
    s_cmpk_ge_u32 s52, 0x100
    s_cbranch_scc1 L_teamA
    s_setprio 2
    s_mov_b32 s6, 2097152
    s_mov_b32 s7, 0x20000
    s_mov_b32 s10, 1572864
    s_mov_b32 s11, 0x20000
    s_add_u32 s58, s47, s45
    v_lshrrev_b32 v36, 3, v0
    v_lshrrev_b32 v37, 4, v0
    v_and_b32 v38, 7, v0
    s_lshl2_add_u32 s52, s44, s46
    s_lshl_b32 s52, s52, 14
    v_xor_b32 v39, v38, v37
    v_lshlrev_b32 v39, 4, v39
    v_lshl_add_u32 v39, v36, 10, v39
    v_add_u32 v1, s52, v39
    v_xor_b32 v2, 64, v1
    v_add_u32 v2, 7168, v2
    s_and_b32 s52, s46, 1
    s_lshl_b32 s52, s52, 2
    v_and_b32 v39, 2, v36
    v_xor_b32 v39, v39, v38
    v_xor_b32 v39, s52, v39
    v_lshlrev_b32 v39, 4, v39
    s_mul_i32 s57, s46, 3072
    s_lshl_b32 s53, s45, 7
    s_lshl3_add_u32 s52, s57, s53
    v_mul_u32_u24 v40, 3072, v36
    v_add3_u32 v3, v39, v40, s52
    s_lshl_b32 s56, s46, 11
    s_and_b32 s58, s58, 7
    s_waitcnt lgkmcnt(0)
L_at_karg_1:
    s_add_u32 m0, s56, 0
    s_lshl_b32 s52, s58, 7
    buffer_load_dwordx4 v1, s[4:7], s52 offen lds
    buffer_load_dwordx4 v2, s[4:7], s52 offen offset:1024 lds
    s_add_u32 m0, s57, 65536
    s_mul_i32 s53, s58, 196608
    buffer_load_dwordx4 v3, s[8:11], s53 offen offset:1024 lds
    buffer_load_dwordx4 v3, s[8:11], s53 offen offset:2048 lds
    buffer_load_dwordx4 v3, s[8:11], s53 offen lds
    s_add_u32 m0, s57, 77824
    s_add_u32 s53, s53, 98304
    buffer_load_dwordx4 v3, s[8:11], s53 offen offset:1024 lds
    buffer_load_dwordx4 v3, s[8:11], s53 offen offset:2048 lds
    buffer_load_dwordx4 v3, s[8:11], s53 offen lds
    s_add_u32 s58, s58, 1
    s_and_b32 s58, s58, 7
L_at_iss8_2:
    s_load_dwordx2 s[24:25], s[0:1], 80
    s_load_dwordx2 s[16:17], s[0:1], 32
    s_load_dwordx2 s[12:13], s[0:1], 16
    s_load_dwordx2 s[20:21], s[0:1], 48
    s_load_dwordx2 s[32:33], s[0:1], 40
    s_load_dwordx2 s[36:37], s[0:1], 56
    s_load_dwordx2 s[28:29], s[0:1], 64
    s_mov_b32 s26, 16777216
    s_mov_b32 s27, 0x20000
    s_mov_b32 s18, 1409024
    s_mov_b32 s19, 0x20000
    s_mov_b32 s14, 524288
    s_mov_b32 s15, 0x20000
    s_mov_b32 s22, 1409024
    s_mov_b32 s23, 0x20000
    s_mov_b32 s34, 2752
    s_mov_b32 s35, 0x20000
    s_mov_b32 s38, 1024
    s_mov_b32 s39, 0x20000
    s_mov_b32 s30, 2097152
    s_mov_b32 s31, 0x20000
    s_lshl_b32 s48, s44, 19
    s_lshl2_add_u32 s67, s45, s46
    s_lshl_b32 s51, s2, 2
    s_and_b32 s51, s51, 12
    v_and_b32 v39, 6, v36
    v_xor_b32 v39, v39, v38
    v_lshlrev_b32 v39, 4, v39
    v_lshl_add_u32 v39, v36, 10, v39
    s_lshl_b32 s52, s46, 13
    s_lshl_b32 s53, s45, 7
    s_add_u32 s52, s52, s53
    v_add_u32 v15, s52, v39
    s_mul_i32 s52, s46, 22016
    s_mul_i32 s54, s45, 352
    s_add_u32 s52, s52, s54
    s_mul_i32 s54, s45, 22
    s_sub_u32 s54, 172, s54
    s_min_u32 s54, s54, 22
    s_mov_b32 s55, 2752
    v_add_u32 v39, 0, v0
    v_mul_u32_u24 v40, 171, v39
    v_lshrrev_b32 v40, 12, v40
    v_mul_u32_u24 v41, 24, v40
    v_sub_u32 v41, v39, v41
    v_and_b32 v42, 6, v40
    v_xor_b32 v41, v41, v42
    v_cmp_gt_u32 s[60:61], s54, v41
    v_lshlrev_b32 v41, 4, v41
    v_mad_u32_u24 v41, v40, s55, v41
    v_add_u32 v41, s52, v41
    v_mov_b32 v42, 0x4000000
    v_cndmask_b32 v4, v42, v41, s[60:61]
    v_add_u32 v39, 64, v0
    v_mul_u32_u24 v40, 171, v39
    v_lshrrev_b32 v40, 12, v40
    v_mul_u32_u24 v41, 24, v40
    v_sub_u32 v41, v39, v41
    v_and_b32 v42, 6, v40
    v_xor_b32 v41, v41, v42
    v_cmp_gt_u32 s[60:61], s54, v41
    v_lshlrev_b32 v41, 4, v41
    v_mad_u32_u24 v41, v40, s55, v41
    v_add_u32 v41, s52, v41
    v_subrev_u32 v41, 1024, v41
    v_mov_b32 v42, 0x4000000
    v_cndmask_b32 v5, v42, v41, s[60:61]
    v_add_u32 v39, 128, v0
    v_mul_u32_u24 v40, 171, v39
    v_lshrrev_b32 v40, 12, v40
    v_mul_u32_u24 v41, 24, v40
    v_sub_u32 v41, v39, v41
    v_and_b32 v42, 6, v40
    v_xor_b32 v41, v41, v42
    v_cmp_gt_u32 s[60:61], s54, v41
    v_lshlrev_b32 v41, 4, v41
    v_mad_u32_u24 v41, v40, s55, v41
    v_add_u32 v41, s52, v41
    v_subrev_u32 v41, 2048, v41
    v_mov_b32 v42, 0x4000000
    v_cndmask_b32 v6, v42, v41, s[60:61]
    v_lshrrev_b32 v39, 2, v0
    v_bfe_u32 v40, v0, 3, 2
    v_and_b32 v41, 3, v0
    v_lshlrev_b32 v41, 3, v41
    v_mul_u32_u24 v39, 384, v39
    v_add_u32 v39, v39, v41
    v_add_u32 v39, 98304, v39
    s_mul_i32 s52, s46, 3
    v_xor_b32 v41, s52, v40
    v_lshl_add_u32 v7, v41, 5, v39
    s_add_u32 s52, s52, 1
    v_xor_b32 v41, s52, v40
    v_lshl_add_u32 v8, v41, 5, v39
    s_add_u32 s52, s52, 1
    v_xor_b32 v41, s52, v40
    v_lshl_add_u32 v9, v41, 5, v39
    s_add_u32 s52, s52, 1
    v_and_b32 v39, 15, v0
    v_lshrrev_b32 v40, 1, v39
    v_xor_b32 v40, v40, v37
    v_lshlrev_b32 v40, 4, v40
    v_lshl_add_u32 v40, v39, 7, v40
    v_add_u32 v10, s56, v40
    v_xor_b32 v11, 64, v10
    s_lshl_b32 s52, s46, 6
    s_add_u32 s52, s52, 159744
    v_lshl_add_u32 v38, v39, 2, s52
    v_and_b32 v36, 3, v0
    v_cmp_eq_u32 s[60:61], 1, v36
    v_cmp_eq_u32 s[62:63], 2, v36
    v_cmp_eq_u32 s[64:65], 3, v36
    v_mov_b32 v16, 0
    v_mov_b32 v17, 0
    v_mov_b32 v18, 0
    v_mov_b32 v19, 0
    s_mov_b32 exec_lo, 0x11111111
    s_mov_b32 exec_hi, 0x11111111
    v_mov_b32 v16, 0x3f803f80
    v_mov_b32 v17, 0x3f803f80
    v_mov_b32 v18, 0x3f803f80
    v_mov_b32 v19, 0x3f803f80
    s_mov_b64 exec, -1
    v_mov_b32 v14, 160272
    v_mov_b32 v63, 0
    s_mov_b32 s59, s51
    s_waitcnt lgkmcnt(0)
    ds_write_b32 v14, v63
    v_lshlrev_b32 v37, 4, v0
    v_add_u32 v37, 160780, v37
    ds_write_b32 v37, v63
    s_mul_i32 s52, s45, 352
    s_mul_i32 s53, s46, 96
    s_add_u32 s52, s52, s53
    v_and_b32 v36, 15, v0
    v_lshlrev_b32 v36, 1, v36
    buffer_load_ushort v60, v36, s[32:35], s52 offen offset:0
    buffer_load_ushort v61, v36, s[32:35], s52 offen offset:32
    buffer_load_ushort v62, v36, s[32:35], s52 offen offset:64
    s_mov_b32 m0, 160384
    v_lshlrev_b32 v36, 2, v0
    s_lshl_b32 s52, s45, 7
    s_mov_b32 exec_hi, 0
    buffer_load_dword v36, s[36:39], s52 offen lds
    s_mov_b32 exec_hi, -1
    s_add_u32 m0, s56, 8192
    s_lshl_b32 s52, s58, 7
    buffer_load_dwordx4 v1, s[4:7], s52 offen lds
    buffer_load_dwordx4 v2, s[4:7], s52 offen offset:1024 lds
    s_add_u32 m0, s57, 90112
    s_mul_i32 s53, s58, 196608
    buffer_load_dwordx4 v3, s[8:11], s53 offen offset:1024 lds
    buffer_load_dwordx4 v3, s[8:11], s53 offen offset:2048 lds
    v_mov_b32 v63, 1
    s_waitcnt vmcnt(11) lgkmcnt(0)
    s_barrier
L_at_bar0_3:
    ds_read_b128 v[28:31], v10 offset:0
    buffer_load_dwordx4 v3, s[8:11], s53 offen lds
    s_add_u32 m0, s57, 102400
    s_add_u32 s53, s53, 98304
    buffer_load_dwordx4 v3, s[8:11], s53 offen offset:1024 lds
    buffer_load_dwordx4 v3, s[8:11], s53 offen offset:2048 lds
    buffer_load_dwordx4 v3, s[8:11], s53 offen lds
    s_add_u32 s58, s58, 1
    s_and_b32 s58, s58, 7
    s_waitcnt vmcnt(12) lgkmcnt(0)
    s_barrier
    ds_read_b128 v[32:35], v11 offset:0
    v_mfma_f32_16x16x32_bf16 v[20:23], v[16:19], v[28:31], 0
    v_mfma_f32_16x16x32_bf16 v[24:27], v[28:31], v[28:31], 0
    s_add_u32 m0, s56, 16384
    s_lshl_b32 s52, s58, 7
    buffer_load_dwordx4 v1, s[4:7], s52 offen lds
    buffer_load_dwordx4 v2, s[4:7], s52 offen offset:1024 lds
    s_add_u32 m0, s57, 114688
    s_mul_i32 s53, s58, 196608
    buffer_load_dwordx4 v3, s[8:11], s53 offen offset:1024 lds
    buffer_load_dwordx4 v3, s[8:11], s53 offen offset:2048 lds
    s_waitcnt vmcnt(7) lgkmcnt(0)
    s_barrier
L_at_bar2_4:
    ds_read_b128 v[28:31], v10 offset:8192
    v_mfma_f32_16x16x32_bf16 v[20:23], v[16:19], v[32:35], v[20:23]
    v_mfma_f32_16x16x32_bf16 v[24:27], v[32:35], v[32:35], v[24:27]
    buffer_load_dwordx4 v3, s[8:11], s53 offen lds
    s_add_u32 m0, s57, 126976
    s_add_u32 s53, s53, 98304
    buffer_load_dwordx4 v3, s[8:11], s53 offen offset:1024 lds
    buffer_load_dwordx4 v3, s[8:11], s53 offen offset:2048 lds
    buffer_load_dwordx4 v3, s[8:11], s53 offen lds
    s_add_u32 s58, s58, 1
    s_and_b32 s58, s58, 7
    s_waitcnt vmcnt(8) lgkmcnt(0)
    s_barrier
    ds_read_b128 v[32:35], v11 offset:8192
    v_mfma_f32_16x16x32_bf16 v[20:23], v[16:19], v[28:31], v[20:23]
    v_mfma_f32_16x16x32_bf16 v[24:27], v[28:31], v[28:31], v[24:27]
    s_add_u32 m0, s56, 24576
    s_lshl_b32 s52, s58, 7
    buffer_load_dwordx4 v1, s[4:7], s52 offen lds
    buffer_load_dwordx4 v2, s[4:7], s52 offen offset:1024 lds
    s_add_u32 m0, s57, 65536
    s_mul_i32 s53, s58, 196608
    buffer_load_dwordx4 v3, s[8:11], s53 offen offset:1024 lds
    buffer_load_dwordx4 v3, s[8:11], s53 offen offset:2048 lds
    s_waitcnt vmcnt(7) lgkmcnt(0)
    s_barrier
L_at_bar4_5:
    ds_read_b128 v[28:31], v10 offset:16384
    v_mfma_f32_16x16x32_bf16 v[20:23], v[16:19], v[32:35], v[20:23]
    v_mfma_f32_16x16x32_bf16 v[24:27], v[32:35], v[32:35], v[24:27]
    buffer_load_dwordx4 v3, s[8:11], s53 offen lds
    s_add_u32 m0, s57, 77824
    s_add_u32 s53, s53, 98304
    buffer_load_dwordx4 v3, s[8:11], s53 offen offset:1024 lds
    buffer_load_dwordx4 v3, s[8:11], s53 offen offset:2048 lds
    buffer_load_dwordx4 v3, s[8:11], s53 offen lds
    s_add_u32 s58, s58, 1
    s_and_b32 s58, s58, 7
    s_waitcnt vmcnt(8) lgkmcnt(0)
    s_barrier
    ds_read_b128 v[32:35], v11 offset:16384
    v_mfma_f32_16x16x32_bf16 v[20:23], v[16:19], v[28:31], v[20:23]
    v_mfma_f32_16x16x32_bf16 v[24:27], v[28:31], v[28:31], v[24:27]
    s_add_u32 m0, s56, 32768
    s_lshl_b32 s52, s58, 7
    buffer_load_dwordx4 v1, s[4:7], s52 offen lds
    buffer_load_dwordx4 v2, s[4:7], s52 offen offset:1024 lds
    s_add_u32 m0, s57, 90112
    s_mul_i32 s53, s58, 196608
    buffer_load_dwordx4 v3, s[8:11], s53 offen offset:1024 lds
    buffer_load_dwordx4 v3, s[8:11], s53 offen offset:2048 lds
    s_waitcnt vmcnt(7) lgkmcnt(0)
    s_barrier
    ds_read_b128 v[28:31], v10 offset:24576
    v_mfma_f32_16x16x32_bf16 v[20:23], v[16:19], v[32:35], v[20:23]
    v_mfma_f32_16x16x32_bf16 v[24:27], v[32:35], v[32:35], v[24:27]
    buffer_load_dwordx4 v3, s[8:11], s53 offen lds
    s_add_u32 m0, s57, 102400
    s_add_u32 s53, s53, 98304
    buffer_load_dwordx4 v3, s[8:11], s53 offen offset:1024 lds
    buffer_load_dwordx4 v3, s[8:11], s53 offen offset:2048 lds
    buffer_load_dwordx4 v3, s[8:11], s53 offen lds
    s_add_u32 s58, s58, 1
    s_and_b32 s58, s58, 7
    s_waitcnt vmcnt(8) lgkmcnt(0)
    s_barrier
    ds_read_b128 v[32:35], v11 offset:24576
    v_mfma_f32_16x16x32_bf16 v[20:23], v[16:19], v[28:31], v[20:23]
    v_mfma_f32_16x16x32_bf16 v[24:27], v[28:31], v[28:31], v[24:27]
    s_add_u32 m0, s56, 40960
    s_lshl_b32 s52, s58, 7
    buffer_load_dwordx4 v1, s[4:7], s52 offen lds
    buffer_load_dwordx4 v2, s[4:7], s52 offen offset:1024 lds
    s_add_u32 m0, s57, 114688
    s_mul_i32 s53, s58, 196608
    buffer_load_dwordx4 v3, s[8:11], s53 offen offset:1024 lds
    buffer_load_dwordx4 v3, s[8:11], s53 offen offset:2048 lds
    s_waitcnt vmcnt(7) lgkmcnt(0)
    s_barrier
L_at_bar8_6:
    ds_read_b128 v[28:31], v10 offset:32768
    v_mfma_f32_16x16x32_bf16 v[20:23], v[16:19], v[32:35], v[20:23]
    v_mfma_f32_16x16x32_bf16 v[24:27], v[32:35], v[32:35], v[24:27]
    buffer_load_dwordx4 v3, s[8:11], s53 offen lds
    s_add_u32 m0, s57, 126976
    s_add_u32 s53, s53, 98304
    buffer_load_dwordx4 v3, s[8:11], s53 offen offset:1024 lds
    buffer_load_dwordx4 v3, s[8:11], s53 offen offset:2048 lds
    buffer_load_dwordx4 v3, s[8:11], s53 offen lds
    s_add_u32 s58, s58, 1
    s_and_b32 s58, s58, 7
    s_waitcnt vmcnt(8) lgkmcnt(0)
    s_barrier
    ds_read_b128 v[32:35], v11 offset:32768
    v_mfma_f32_16x16x32_bf16 v[20:23], v[16:19], v[28:31], v[20:23]
    v_mfma_f32_16x16x32_bf16 v[24:27], v[28:31], v[28:31], v[24:27]
    s_add_u32 m0, s56, 49152
    s_lshl_b32 s52, s58, 7
    buffer_load_dwordx4 v1, s[4:7], s52 offen lds
    buffer_load_dwordx4 v2, s[4:7], s52 offen offset:1024 lds
    s_add_u32 m0, s57, 65536
    s_mul_i32 s53, s58, 196608
    buffer_load_dwordx4 v3, s[8:11], s53 offen offset:1024 lds
    buffer_load_dwordx4 v3, s[8:11], s53 offen offset:2048 lds
    s_waitcnt vmcnt(7) lgkmcnt(0)
    s_barrier
    ds_read_b128 v[28:31], v10 offset:40960
    v_mfma_f32_16x16x32_bf16 v[20:23], v[16:19], v[32:35], v[20:23]
    v_mfma_f32_16x16x32_bf16 v[24:27], v[32:35], v[32:35], v[24:27]
    buffer_load_dwordx4 v3, s[8:11], s53 offen lds
    s_add_u32 m0, s57, 77824
    s_add_u32 s53, s53, 98304
    buffer_load_dwordx4 v3, s[8:11], s53 offen offset:1024 lds
    buffer_load_dwordx4 v3, s[8:11], s53 offen offset:2048 lds
    buffer_load_dwordx4 v3, s[8:11], s53 offen lds
    s_add_u32 s58, s58, 1
    s_and_b32 s58, s58, 7
    s_waitcnt vmcnt(8) lgkmcnt(0)
    s_barrier
    ds_read_b128 v[32:35], v11 offset:40960
    v_mfma_f32_16x16x32_bf16 v[20:23], v[16:19], v[28:31], v[20:23]
    v_mfma_f32_16x16x32_bf16 v[24:27], v[28:31], v[28:31], v[24:27]
    s_add_u32 m0, s56, 57344
    s_lshl_b32 s52, s58, 7
    buffer_load_dwordx4 v1, s[4:7], s52 offen lds
    buffer_load_dwordx4 v2, s[4:7], s52 offen offset:1024 lds
    s_add_u32 m0, s57, 90112
    s_mul_i32 s53, s58, 196608
    buffer_load_dwordx4 v3, s[8:11], s53 offen offset:1024 lds
    buffer_load_dwordx4 v3, s[8:11], s53 offen offset:2048 lds
    s_waitcnt vmcnt(7) lgkmcnt(0)
    s_barrier
L_at_bar12_7:
    ds_read_b128 v[28:31], v10 offset:49152
    v_mfma_f32_16x16x32_bf16 v[20:23], v[16:19], v[32:35], v[20:23]
    v_mfma_f32_16x16x32_bf16 v[24:27], v[32:35], v[32:35], v[24:27]
    buffer_load_dwordx4 v3, s[8:11], s53 offen lds
    s_add_u32 m0, s57, 102400
    s_add_u32 s53, s53, 98304
    buffer_load_dwordx4 v3, s[8:11], s53 offen offset:1024 lds
    buffer_load_dwordx4 v3, s[8:11], s53 offen offset:2048 lds
    buffer_load_dwordx4 v3, s[8:11], s53 offen lds
    s_add_u32 s58, s58, 1
    s_and_b32 s58, s58, 7
    s_waitcnt vmcnt(8) lgkmcnt(0)
    s_barrier
L_at_bar13_8:
    ds_read_b128 v[32:35], v11 offset:49152
    v_mfma_f32_16x16x32_bf16 v[20:23], v[16:19], v[28:31], v[20:23]
    v_mfma_f32_16x16x32_bf16 v[24:27], v[28:31], v[28:31], v[24:27]
    s_lshl2_add_u32 s52, s2, s46
    s_mul_i32 s52, s52, 1408
    v_lshlrev_b32 v44, 7, v0
    s_mov_b64 exec, 0x7ff
    buffer_load_dword v45, v44, s[16:19], s52 offen
    s_mov_b64 exec, -1
    s_lshl2_add_u32 s52, s2, s46
    s_mul_i32 s52, s52, 512
    v_lshlrev_b32 v44, 7, v0
    s_mov_b64 exec, 0xf
    buffer_load_dword v46, v44, s[12:15], s52 offen
    s_mov_b64 exec, -1
    s_lshl2_add_u32 s52, s2, s46
    s_mul_i32 s52, s52, 1408
    v_lshlrev_b32 v44, 7, v0
    s_mov_b64 exec, 0x7ff
    buffer_load_dword v47, v44, s[20:23], s52 offen
    s_mov_b64 exec, -1
    s_waitcnt vmcnt(6) lgkmcnt(0)
    s_barrier
L_at_bar14_9:
    ds_read_b128 v[28:31], v10 offset:57344
    v_mfma_f32_16x16x32_bf16 v[20:23], v[16:19], v[32:35], v[20:23]
    v_mfma_f32_16x16x32_bf16 v[24:27], v[32:35], v[32:35], v[24:27]
    s_add_u32 m0, s57, 147456
    s_mul_i32 s52, s59, 88064
    buffer_load_dwordx4 v4, s[16:19], s52 offen lds
    buffer_load_dwordx4 v5, s[16:19], s52 offen offset:1024 lds
    buffer_load_dwordx4 v6, s[16:19], s52 offen offset:2048 lds
    s_add_u32 s59, s59, 1
    s_and_b32 s59, s59, 15
    s_waitcnt vmcnt(6) lgkmcnt(0)
    s_barrier
L_at_bar15_10:
    ds_read_b128 v[32:35], v11 offset:57344
    v_mfma_f32_16x16x32_bf16 v[20:23], v[16:19], v[28:31], v[20:23]
    v_mfma_f32_16x16x32_bf16 v[24:27], v[28:31], v[28:31], v[24:27]
    s_waitcnt lgkmcnt(0)
    v_mfma_f32_16x16x32_bf16 v[20:23], v[16:19], v[32:35], v[20:23]
    v_mfma_f32_16x16x32_bf16 v[24:27], v[32:35], v[32:35], v[24:27]
    s_nop 6
    v_mul_f32 v39, 0xbb000000, v20
    v_cndmask_b32 v37, v24, v25, s[60:61]
    v_cndmask_b32 v37, v37, v26, s[62:63]
    v_cndmask_b32 v37, v37, v27, s[64:65]
    v_mul_f32 v37, 0x3b000000, v37
    v_fma_f32 v37, -v39, v39, v37
    v_max_f32 v37, 0, v37
    v_add_f32 v37, 0x3727c5ac, v37
    v_rsq_f32 v37, v37
    s_mov_b32 exec_lo, 0x00f0000f
    s_mov_b32 exec_hi, 0xf0000f00
    v_mul_f32 v39, v39, v37
    ds_write2st64_b32 v38, v37, v39 offset0:0 offset1:1
    s_mov_b64 exec, -1
    s_waitcnt lgkmcnt(0)
    s_barrier
    s_setprio 2
L_at_S1e_11:
    s_mov_b32 s58, s51
    s_lshl_b32 s55, s46, 10
    s_add_u32 m0, s57, 110592
    s_mul_i32 s52, s59, 88064
    s_waitcnt vmcnt(4)
    buffer_load_dwordx4 v4, s[16:19], s52 offen lds
    s_waitcnt vmcnt(4)
    buffer_load_dwordx4 v5, s[16:19], s52 offen offset:1024 lds
    s_waitcnt vmcnt(4)
    buffer_load_dwordx4 v6, s[16:19], s52 offen offset:2048 lds
    s_add_u32 s59, s59, 1
    s_and_b32 s59, s59, 15
    s_add_u32 m0, s57, 122880
    s_mul_i32 s52, s59, 88064
    s_waitcnt vmcnt(4)
    buffer_load_dwordx4 v4, s[16:19], s52 offen lds
    s_waitcnt vmcnt(4)
    buffer_load_dwordx4 v5, s[16:19], s52 offen offset:1024 lds
    s_waitcnt vmcnt(4)
    buffer_load_dwordx4 v6, s[16:19], s52 offen offset:2048 lds
    s_add_u32 s59, s59, 1
    s_and_b32 s59, s59, 15
    s_mov_b64 exec, 1
    ds_add_u32 v14, v63
    s_mov_b64 exec, -1
    s_add_u32 m0, s57, 135168
    s_mul_i32 s52, s59, 88064
    s_waitcnt vmcnt(4)
    buffer_load_dwordx4 v4, s[16:19], s52 offen lds
    s_waitcnt vmcnt(4)
    buffer_load_dwordx4 v5, s[16:19], s52 offen offset:1024 lds
    s_waitcnt vmcnt(4)
    buffer_load_dwordx4 v6, s[16:19], s52 offen offset:2048 lds
    s_add_u32 s59, s59, 1
    s_and_b32 s59, s59, 15
L_tb12:
    ds_read_b32 v36, v14
    s_waitcnt lgkmcnt(0)
    v_readfirstlane_b32 s54, v36
    s_nop 0
    s_cmp_lt_u32 s54, 4
    s_cbranch_scc1 L_tb12
    ds_read_b64_tr_b16 v[64:65], v7 offset:49152
    ds_read_b64_tr_b16 v[66:67], v7 offset:55296
    ds_read_b64_tr_b16 v[68:69], v8 offset:49152
    ds_read_b64_tr_b16 v[70:71], v8 offset:55296
    ds_read_b64_tr_b16 v[72:73], v9 offset:49152
    ds_read_b64_tr_b16 v[74:75], v9 offset:55296
L_at_dr0_13:
    s_waitcnt lgkmcnt(0)
    s_mov_b64 exec, 1
    ds_add_u32 v14, v63
    s_mov_b64 exec, -1
    s_add_u32 m0, s57, 66560
    s_mul_i32 s52, s59, 88064
    s_waitcnt vmcnt(4)
    buffer_load_dwordx4 v4, s[16:19], s52 offen lds
    s_waitcnt vmcnt(4)
    buffer_load_dwordx4 v5, s[16:19], s52 offen offset:1024 lds
    s_waitcnt vmcnt(4)
    buffer_load_dwordx4 v6, s[16:19], s52 offen offset:2048 lds
    s_add_u32 s59, s59, 1
    s_and_b32 s59, s59, 15
L_tb14:
    ds_read_b32 v36, v14
    s_waitcnt lgkmcnt(0)
    v_readfirstlane_b32 s54, v36
    s_nop 0
    s_cmp_lt_u32 s54, 8
    s_cbranch_scc1 L_tb14
    ds_read_b64_tr_b16 v[76:77], v7 offset:12288
    ds_read_b64_tr_b16 v[78:79], v7 offset:18432
    ds_read_b64_tr_b16 v[80:81], v8 offset:12288
    ds_read_b64_tr_b16 v[82:83], v8 offset:18432
    ds_read_b64_tr_b16 v[84:85], v9 offset:12288
    ds_read_b64_tr_b16 v[86:87], v9 offset:18432
    s_waitcnt lgkmcnt(0)
    s_mov_b64 exec, 1
    ds_add_u32 v14, v63
    s_mov_b64 exec, -1
    s_add_u32 m0, s57, 98304
    s_mul_i32 s52, s59, 88064
    s_waitcnt vmcnt(4)
    buffer_load_dwordx4 v4, s[16:19], s52 offen lds
    s_waitcnt vmcnt(4)
    buffer_load_dwordx4 v5, s[16:19], s52 offen offset:1024 lds
    s_waitcnt vmcnt(4)
    buffer_load_dwordx4 v6, s[16:19], s52 offen offset:2048 lds
    s_add_u32 s59, s59, 1
    s_and_b32 s59, s59, 15
L_tb15:
    ds_read_b32 v36, v14
    s_waitcnt lgkmcnt(0)
    v_readfirstlane_b32 s54, v36
    s_nop 0
    s_cmp_lt_u32 s54, 12
    s_cbranch_scc1 L_tb15
    ds_read_b64_tr_b16 v[88:89], v7 offset:24576
    ds_read_b64_tr_b16 v[90:91], v7 offset:30720
    ds_read_b64_tr_b16 v[92:93], v8 offset:24576
    ds_read_b64_tr_b16 v[94:95], v8 offset:30720
    ds_read_b64_tr_b16 v[96:97], v9 offset:24576
    ds_read_b64_tr_b16 v[98:99], v9 offset:30720
    s_waitcnt lgkmcnt(0)
    s_mov_b64 exec, 1
    ds_add_u32 v14, v63
    s_mov_b64 exec, -1
    s_add_u32 m0, s57, 110592
    s_mul_i32 s52, s59, 88064
    s_waitcnt vmcnt(4)
    buffer_load_dwordx4 v4, s[16:19], s52 offen lds
    s_waitcnt vmcnt(4)
    buffer_load_dwordx4 v5, s[16:19], s52 offen offset:1024 lds
    s_waitcnt vmcnt(4)
    buffer_load_dwordx4 v6, s[16:19], s52 offen offset:2048 lds
    s_add_u32 s59, s59, 1
    s_and_b32 s59, s59, 15
L_tb16:
    ds_read_b32 v36, v14
    s_waitcnt lgkmcnt(0)
    v_readfirstlane_b32 s54, v36
    s_nop 0
    s_cmp_lt_u32 s54, 16
    s_cbranch_scc1 L_tb16
    ds_read_b64_tr_b16 v[100:101], v7 offset:36864
    ds_read_b64_tr_b16 v[102:103], v7 offset:43008
    ds_read_b64_tr_b16 v[104:105], v8 offset:36864
    ds_read_b64_tr_b16 v[106:107], v8 offset:43008
    ds_read_b64_tr_b16 v[108:109], v9 offset:36864
    ds_read_b64_tr_b16 v[110:111], v9 offset:43008
    s_waitcnt lgkmcnt(0)
    s_mov_b64 exec, 1
    ds_add_u32 v14, v63
    s_mov_b64 exec, -1
    s_add_u32 m0, s57, 122880
    s_mul_i32 s52, s59, 88064
    s_waitcnt vmcnt(4)
    buffer_load_dwordx4 v4, s[16:19], s52 offen lds
    s_waitcnt vmcnt(4)
    buffer_load_dwordx4 v5, s[16:19], s52 offen offset:1024 lds
    s_waitcnt vmcnt(4)
    buffer_load_dwordx4 v6, s[16:19], s52 offen offset:2048 lds
    s_add_u32 s59, s59, 1
    s_and_b32 s59, s59, 15
L_tb17:
    ds_read_b32 v36, v14
    s_waitcnt lgkmcnt(0)
    v_readfirstlane_b32 s54, v36
    s_nop 0
    s_cmp_lt_u32 s54, 20
    s_cbranch_scc1 L_tb17
    v_add_u32 v7, 0xffff8400, v7
    v_add_u32 v8, 0xffff8400, v8
    v_add_u32 v9, 0xffff8400, v9
    ds_read_b64_tr_b16 v[112:113], v7 offset:0
    ds_read_b64_tr_b16 v[114:115], v7 offset:6144
    ds_read_b64_tr_b16 v[116:117], v8 offset:0
    ds_read_b64_tr_b16 v[118:119], v8 offset:6144
    ds_read_b64_tr_b16 v[120:121], v9 offset:0
    ds_read_b64_tr_b16 v[122:123], v9 offset:6144
L_at_dr4_18:
    s_waitcnt lgkmcnt(0)
    s_mov_b64 exec, 1
    ds_add_u32 v14, v63
    s_mov_b64 exec, -1
    s_add_u32 m0, s57, 135168
    s_mul_i32 s52, s59, 88064
    s_waitcnt vmcnt(4)
    buffer_load_dwordx4 v4, s[16:19], s52 offen lds
    s_waitcnt vmcnt(4)
    buffer_load_dwordx4 v5, s[16:19], s52 offen offset:1024 lds
    s_waitcnt vmcnt(4)
    buffer_load_dwordx4 v6, s[16:19], s52 offen offset:2048 lds
    s_add_u32 s59, s59, 1
    s_and_b32 s59, s59, 15
    s_lshr_b32 s52, s2, 3
    s_lshl2_add_u32 s52, s52, s46
    s_mul_i32 s52, s52, 4096
    v_lshlrev_b32 v44, 10, v0
    s_mov_b64 exec, 0xf
    buffer_load_dword v45, v44, s[12:15], s52 offen offset:384
    s_mov_b64 exec, -1
L_tb19:
    ds_read_b32 v36, v14
    s_waitcnt lgkmcnt(0)
    v_readfirstlane_b32 s54, v36
    s_nop 0
    s_cmp_lt_u32 s54, 24
    s_cbranch_scc1 L_tb19
    ds_read_b64_tr_b16 v[124:125], v7 offset:31744
    ds_read_b64_tr_b16 v[126:127], v7 offset:37888
    ds_read_b64_tr_b16 v[128:129], v8 offset:31744
    ds_read_b64_tr_b16 v[130:131], v8 offset:37888
    ds_read_b64_tr_b16 v[132:133], v9 offset:31744
    ds_read_b64_tr_b16 v[134:135], v9 offset:37888
    s_waitcnt lgkmcnt(0)
    s_mov_b64 exec, 1
    ds_add_u32 v14, v63
    s_mov_b64 exec, -1
    s_add_u32 m0, s57, 147456
    s_mul_i32 s52, s59, 88064
    s_waitcnt vmcnt(4)
    buffer_load_dwordx4 v4, s[16:19], s52 offen lds
    s_waitcnt vmcnt(4)
    buffer_load_dwordx4 v5, s[16:19], s52 offen offset:1024 lds
    s_waitcnt vmcnt(4)
    buffer_load_dwordx4 v6, s[16:19], s52 offen offset:2048 lds
    s_add_u32 s59, s59, 1
    s_and_b32 s59, s59, 15
L_tb20:
    ds_read_b32 v36, v14
    s_waitcnt lgkmcnt(0)
    v_readfirstlane_b32 s54, v36
    s_nop 0
    s_cmp_lt_u32 s54, 28
    s_cbranch_scc1 L_tb20
    ds_read_b64_tr_b16 v[136:137], v7 offset:44032
    ds_read_b64_tr_b16 v[138:139], v7 offset:50176
    ds_read_b64_tr_b16 v[140:141], v8 offset:44032
    ds_read_b64_tr_b16 v[142:143], v8 offset:50176
    ds_read_b64_tr_b16 v[144:145], v9 offset:44032
    ds_read_b64_tr_b16 v[146:147], v9 offset:50176
    s_waitcnt lgkmcnt(0)
    s_mov_b64 exec, 1
    ds_add_u32 v14, v63
    s_mov_b64 exec, -1
    s_add_u32 m0, s57, 66560
    s_mul_i32 s52, s59, 88064
    s_waitcnt vmcnt(4)
    buffer_load_dwordx4 v4, s[16:19], s52 offen lds
    s_waitcnt vmcnt(4)
    buffer_load_dwordx4 v5, s[16:19], s52 offen offset:1024 lds
    s_waitcnt vmcnt(4)
    buffer_load_dwordx4 v6, s[16:19], s52 offen offset:2048 lds
    s_add_u32 s59, s59, 1
    s_and_b32 s59, s59, 15
L_tb21:
    ds_read_b32 v36, v14
    s_waitcnt lgkmcnt(0)
    v_readfirstlane_b32 s54, v36
    s_nop 0
    s_cmp_lt_u32 s54, 32
    s_cbranch_scc1 L_tb21
    ds_read_b64_tr_b16 v[148:149], v7 offset:56320
    ds_read_b64_tr_b16 v[150:151], v7 offset:62464
    ds_read_b64_tr_b16 v[152:153], v8 offset:56320
    ds_read_b64_tr_b16 v[154:155], v8 offset:62464
    ds_read_b64_tr_b16 v[156:157], v9 offset:56320
    ds_read_b64_tr_b16 v[158:159], v9 offset:62464
    s_waitcnt lgkmcnt(0)
    s_mov_b64 exec, 1
    ds_add_u32 v14, v63
    s_mov_b64 exec, -1
    s_add_u32 m0, s57, 78848
    s_mul_i32 s52, s59, 88064
    s_waitcnt vmcnt(4)
    buffer_load_dwordx4 v4, s[16:19], s52 offen lds
    s_waitcnt vmcnt(4)
    buffer_load_dwordx4 v5, s[16:19], s52 offen offset:1024 lds
    s_waitcnt vmcnt(4)
    buffer_load_dwordx4 v6, s[16:19], s52 offen offset:2048 lds
    s_add_u32 s59, s59, 1
    s_and_b32 s59, s59, 15
L_tb22:
    ds_read_b32 v36, v14
    s_waitcnt lgkmcnt(0)
    v_readfirstlane_b32 s54, v36
    s_nop 0
    s_cmp_lt_u32 s54, 36
    s_cbranch_scc1 L_tb22
    v_add_u32 v7, 0x10c00, v7
    v_add_u32 v8, 0x10c00, v8
    v_add_u32 v9, 0x10c00, v9
    ds_read_b64_tr_b16 v[160:161], v7 offset:0
    ds_read_b64_tr_b16 v[162:163], v7 offset:6144
    ds_read_b64_tr_b16 v[164:165], v8 offset:0
    ds_read_b64_tr_b16 v[166:167], v8 offset:6144
    ds_read_b64_tr_b16 v[168:169], v9 offset:0
    ds_read_b64_tr_b16 v[170:171], v9 offset:6144
    s_waitcnt lgkmcnt(0)
    s_mov_b64 exec, 1
    ds_add_u32 v14, v63
    s_mov_b64 exec, -1
    s_add_u32 m0, s55, 94208
    s_lshl_b32 s52, s58, 15
    s_waitcnt vmcnt(4)
    buffer_load_dwordx4 v15, s[12:15], s52 offen lds
    s_add_u32 s58, s58, 1
    s_and_b32 s58, s58, 15
    s_add_u32 m0, s55, 98304
    s_lshl_b32 s52, s58, 15
    s_waitcnt vmcnt(4)
    buffer_load_dwordx4 v15, s[12:15], s52 offen lds
    s_add_u32 s58, s58, 1
    s_and_b32 s58, s58, 15
    s_add_u32 m0, s55, 102400
    s_lshl_b32 s52, s58, 15
    s_waitcnt vmcnt(4)
    buffer_load_dwordx4 v15, s[12:15], s52 offen lds
    s_add_u32 s58, s58, 1
    s_and_b32 s58, s58, 15
L_tb23:
    ds_read_b32 v36, v14
    s_waitcnt lgkmcnt(0)
    v_readfirstlane_b32 s54, v36
    s_nop 0
    s_cmp_lt_u32 s54, 40
    s_cbranch_scc1 L_tb23
    ds_read_b64_tr_b16 v[172:173], v7 offset:12288
    ds_read_b64_tr_b16 v[174:175], v7 offset:18432
    ds_read_b64_tr_b16 v[176:177], v8 offset:12288
    ds_read_b64_tr_b16 v[178:179], v8 offset:18432
    ds_read_b64_tr_b16 v[180:181], v9 offset:12288
    ds_read_b64_tr_b16 v[182:183], v9 offset:18432
L_at_dr9_24:
    s_waitcnt lgkmcnt(0)
    s_mov_b64 exec, 1
    ds_add_u32 v14, v63
    s_mov_b64 exec, -1
    s_add_u32 m0, s55, 106496
    s_lshl_b32 s52, s58, 15
    s_waitcnt vmcnt(4)
    buffer_load_dwordx4 v15, s[12:15], s52 offen lds
    s_add_u32 s58, s58, 1
    s_and_b32 s58, s58, 15
    s_add_u32 m0, s55, 110592
    s_lshl_b32 s52, s58, 15
    s_waitcnt vmcnt(4)
    buffer_load_dwordx4 v15, s[12:15], s52 offen lds
    s_add_u32 s58, s58, 1
    s_and_b32 s58, s58, 15
    s_add_u32 m0, s55, 114688
    s_lshl_b32 s52, s58, 15
    s_waitcnt vmcnt(4)
    buffer_load_dwordx4 v15, s[12:15], s52 offen lds
    s_add_u32 s58, s58, 1
    s_and_b32 s58, s58, 15
L_tb25:
    ds_read_b32 v36, v14
    s_waitcnt lgkmcnt(0)
    v_readfirstlane_b32 s54, v36
    s_nop 0
    s_cmp_lt_u32 s54, 44
    s_cbranch_scc1 L_tb25
    v_add_u32 v7, 0xfffef400, v7
    v_add_u32 v8, 0xfffef400, v8
    v_add_u32 v9, 0xfffef400, v9
    ds_read_b64_tr_b16 v[184:185], v7 offset:0
    ds_read_b64_tr_b16 v[186:187], v7 offset:6144
    ds_read_b64_tr_b16 v[188:189], v8 offset:0
    ds_read_b64_tr_b16 v[190:191], v8 offset:6144
    ds_read_b64_tr_b16 v[192:193], v9 offset:0
    ds_read_b64_tr_b16 v[194:195], v9 offset:6144
    s_waitcnt lgkmcnt(0)
    s_mov_b64 exec, 1
    ds_add_u32 v14, v63
    s_mov_b64 exec, -1
    s_add_u32 m0, s55, 118784
    s_lshl_b32 s52, s58, 15
    s_waitcnt vmcnt(4)
    buffer_load_dwordx4 v15, s[12:15], s52 offen lds
    s_add_u32 s58, s58, 1
    s_and_b32 s58, s58, 15
    s_add_u32 m0, s55, 122880
    s_lshl_b32 s52, s58, 15
    s_waitcnt vmcnt(4)
    buffer_load_dwordx4 v15, s[12:15], s52 offen lds
    s_add_u32 s58, s58, 1
    s_and_b32 s58, s58, 15
    s_add_u32 m0, s55, 126976
    s_lshl_b32 s52, s58, 15
    s_waitcnt vmcnt(4)
    buffer_load_dwordx4 v15, s[12:15], s52 offen lds
    s_add_u32 s58, s58, 1
    s_and_b32 s58, s58, 15
L_tb26:
    ds_read_b32 v36, v14
    s_waitcnt lgkmcnt(0)
    v_readfirstlane_b32 s54, v36
    s_nop 0
    s_cmp_lt_u32 s54, 48
    s_cbranch_scc1 L_tb26
    ds_read_b64_tr_b16 v[196:197], v7 offset:12288
    ds_read_b64_tr_b16 v[198:199], v7 offset:18432
    ds_read_b64_tr_b16 v[200:201], v8 offset:12288
    ds_read_b64_tr_b16 v[202:203], v8 offset:18432
    ds_read_b64_tr_b16 v[204:205], v9 offset:12288
    ds_read_b64_tr_b16 v[206:207], v9 offset:18432
    s_add_u32 m0, s55, 131072
    s_lshl_b32 s52, s58, 15
    s_waitcnt vmcnt(4)
    buffer_load_dwordx4 v15, s[12:15], s52 offen lds
    s_add_u32 s58, s58, 1
    s_and_b32 s58, s58, 15
    s_add_u32 m0, s55, 135168
    s_lshl_b32 s52, s58, 15
    s_waitcnt vmcnt(4)
    buffer_load_dwordx4 v15, s[12:15], s52 offen lds
    s_add_u32 s58, s58, 1
    s_and_b32 s58, s58, 15
    s_add_u32 m0, s55, 139264
    s_lshl_b32 s52, s58, 15
    s_waitcnt vmcnt(4)
    buffer_load_dwordx4 v15, s[12:15], s52 offen lds
    s_add_u32 s58, s58, 1
    s_and_b32 s58, s58, 15
    s_add_u32 m0, s55, 143360
    s_lshl_b32 s52, s58, 15
    s_waitcnt vmcnt(4)
    buffer_load_dwordx4 v15, s[12:15], s52 offen lds
    s_add_u32 s58, s58, 1
    s_and_b32 s58, s58, 15
    s_add_u32 m0, s55, 147456
    s_lshl_b32 s52, s58, 15
    s_waitcnt vmcnt(4)
    buffer_load_dwordx4 v15, s[12:15], s52 offen lds
    s_add_u32 s58, s58, 1
    s_and_b32 s58, s58, 15
    s_add_u32 m0, s55, 151552
    s_lshl_b32 s52, s58, 15
    s_waitcnt vmcnt(4)
    buffer_load_dwordx4 v15, s[12:15], s52 offen lds
    s_add_u32 s58, s58, 1
    s_and_b32 s58, s58, 15
    s_add_u32 m0, s55, 155648
    s_lshl_b32 s52, s58, 15
    s_waitcnt vmcnt(4)
    buffer_load_dwordx4 v15, s[12:15], s52 offen lds
    s_add_u32 s58, s58, 1
    s_and_b32 s58, s58, 15
    s_lshr_b32 s52, s2, 3
    s_lshl2_add_u32 s52, s52, s46
    s_mul_i32 s52, s52, 11264
    v_lshlrev_b32 v44, 10, v0
    s_mov_b64 exec, 0x7ff
    buffer_load_dword v45, v44, s[20:23], s52 offen offset:384
    s_mov_b64 exec, -1
    s_setprio 0
    v_lshlrev_b32 v1, 4, v0
    v_add_u32 v1, 61440, v1
    v_and_b32 v36, 15, v0
    v_lshlrev_b32 v36, 4, v36
    v_add_u32 v2, 160768, v36
    v_lshlrev_b32 v3, 3, v0
    v_add_u32 v3, 161792, v3
    s_mul_i32 s52, s45, 11
    s_mul_i32 s53, s46, 3
    s_add_u32 s52, s52, s53
    s_lshl_b32 s52, s52, 10
    s_add_u32 s52, s52, 131072
    s_add_u32 s52, s52, s48
    v_lshrrev_b32 v37, 4, v0
    v_cmp_eq_u32 s[62:63], 0, v37
    v_cmp_eq_u32 s[64:65], 1, v37
    v_lshl_add_u32 v38, v37, 9, v36
    v_add_u32 v10, s52, v38
    v_lshrrev_b32 v38, 5, v0
    v_lshl_add_u32 v38, v38, 9, v36
    v_and_b32 v37, 1, v37
    v_lshl_add_u32 v38, v37, 3, v38
    s_add_u32 s52, s52, 2048
    s_cmp_eq_u32 s46, 3
    s_cselect_b32 s52, 0x4000000, s52
    v_add_u32 v11, s52, v38
    s_mov_b32 s4, 90112
    v_mov_b32 v16, 0
    v_mov_b32 v17, 0
    v_mov_b32 v18, 0
    v_mov_b32 v19, 0
    s_mov_b32 exec_lo, 0x100010
    s_mov_b32 exec_hi, 0x100010
    v_mov_b32 v16, 0x3f803f80
    v_mov_b32 v17, 0x3f803f80
    v_mov_b32 v18, 0x3f803f80
    v_mov_b32 v19, 0x3f803f80
    s_mov_b64 exec, -1
L_at_preE_27:
    s_waitcnt vmcnt(1) lgkmcnt(0)
    s_barrier
L_at_E_28:
    v_mov_b32 v36, 160256
    ds_read_b64 v[38:39], v36
    v_mfma_f32_16x16x32_bf16 v[48:51], v[16:19], v[64:67], 0
    v_mfma_f32_16x16x32_bf16 v[52:55], v[16:19], v[68:71], 0
    v_mfma_f32_16x16x32_bf16 v[56:59], v[16:19], v[72:75], 0
    v_mfma_f32_16x16x32_bf16 v[48:51], v[16:19], v[76:79], v[48:51]
    v_mfma_f32_16x16x32_bf16 v[52:55], v[16:19], v[80:83], v[52:55]
    v_mfma_f32_16x16x32_bf16 v[56:59], v[16:19], v[84:87], v[56:59]
    v_mfma_f32_16x16x32_bf16 v[48:51], v[16:19], v[88:91], v[48:51]
    v_mfma_f32_16x16x32_bf16 v[52:55], v[16:19], v[92:95], v[52:55]
    v_mfma_f32_16x16x32_bf16 v[56:59], v[16:19], v[96:99], v[56:59]
    v_mfma_f32_16x16x32_bf16 v[48:51], v[16:19], v[100:103], v[48:51]
    v_mfma_f32_16x16x32_bf16 v[52:55], v[16:19], v[104:107], v[52:55]
    v_mfma_f32_16x16x32_bf16 v[56:59], v[16:19], v[108:111], v[56:59]
    v_mfma_f32_16x16x32_bf16 v[48:51], v[16:19], v[112:115], v[48:51]
    v_mfma_f32_16x16x32_bf16 v[52:55], v[16:19], v[116:119], v[52:55]
    v_mfma_f32_16x16x32_bf16 v[56:59], v[16:19], v[120:123], v[56:59]
    v_mfma_f32_16x16x32_bf16 v[48:51], v[16:19], v[124:127], v[48:51]
    v_mfma_f32_16x16x32_bf16 v[52:55], v[16:19], v[128:131], v[52:55]
    v_mfma_f32_16x16x32_bf16 v[56:59], v[16:19], v[132:135], v[56:59]
    v_mfma_f32_16x16x32_bf16 v[48:51], v[16:19], v[136:139], v[48:51]
    v_mfma_f32_16x16x32_bf16 v[52:55], v[16:19], v[140:143], v[52:55]
    v_mfma_f32_16x16x32_bf16 v[56:59], v[16:19], v[144:147], v[56:59]
    v_mfma_f32_16x16x32_bf16 v[48:51], v[16:19], v[148:151], v[48:51]
    v_mfma_f32_16x16x32_bf16 v[52:55], v[16:19], v[152:155], v[52:55]
    v_mfma_f32_16x16x32_bf16 v[56:59], v[16:19], v[156:159], v[56:59]
    v_mfma_f32_16x16x32_bf16 v[48:51], v[16:19], v[160:163], v[48:51]
    v_mfma_f32_16x16x32_bf16 v[52:55], v[16:19], v[164:167], v[52:55]
    v_mfma_f32_16x16x32_bf16 v[56:59], v[16:19], v[168:171], v[56:59]
    v_mfma_f32_16x16x32_bf16 v[48:51], v[16:19], v[172:175], v[48:51]
    v_mfma_f32_16x16x32_bf16 v[52:55], v[16:19], v[176:179], v[52:55]
    v_mfma_f32_16x16x32_bf16 v[56:59], v[16:19], v[180:183], v[56:59]
    v_mfma_f32_16x16x32_bf16 v[48:51], v[16:19], v[184:187], v[48:51]
    v_mfma_f32_16x16x32_bf16 v[52:55], v[16:19], v[188:191], v[52:55]
    v_mfma_f32_16x16x32_bf16 v[56:59], v[16:19], v[192:195], v[56:59]
    v_mfma_f32_16x16x32_bf16 v[48:51], v[16:19], v[196:199], v[48:51]
    v_mfma_f32_16x16x32_bf16 v[52:55], v[16:19], v[200:203], v[52:55]
    v_mfma_f32_16x16x32_bf16 v[56:59], v[16:19], v[204:207], v[56:59]
    s_add_u32 m0, s57, 0
    s_mul_i32 s52, s59, 88064
    buffer_load_dwordx4 v4, s[16:19], s52 offen lds
    buffer_load_dwordx4 v5, s[16:19], s52 offen offset:1024 lds
    buffer_load_dwordx4 v6, s[16:19], s52 offen offset:2048 lds
    s_add_u32 s59, s59, 1
    s_and_b32 s59, s59, 15
    s_add_u32 m0, s57, 12288
    s_mul_i32 s52, s59, 88064
    buffer_load_dwordx4 v4, s[16:19], s52 offen lds
    buffer_load_dwordx4 v5, s[16:19], s52 offen offset:1024 lds
    s_waitcnt vmcnt(5)
    buffer_load_dwordx4 v6, s[16:19], s52 offen offset:2048 lds
    s_add_u32 s59, s59, 1
    s_and_b32 s59, s59, 15
    s_add_u32 m0, s57, 24576
    s_mul_i32 s52, s59, 88064
    s_waitcnt vmcnt(5)
    buffer_load_dwordx4 v4, s[16:19], s52 offen lds
    s_waitcnt vmcnt(5)
    buffer_load_dwordx4 v5, s[16:19], s52 offen offset:1024 lds
    s_waitcnt vmcnt(5)
    buffer_load_dwordx4 v6, s[16:19], s52 offen offset:2048 lds
    s_add_u32 s59, s59, 1
    s_and_b32 s59, s59, 15
    s_add_u32 m0, s57, 36864
    s_mul_i32 s52, s59, 88064
    s_waitcnt vmcnt(5)
    buffer_load_dwordx4 v4, s[16:19], s52 offen lds
    s_waitcnt vmcnt(5)
    buffer_load_dwordx4 v5, s[16:19], s52 offen offset:1024 lds
    s_waitcnt vmcnt(5)
    buffer_load_dwordx4 v6, s[16:19], s52 offen offset:2048 lds
    s_add_u32 s59, s59, 1
    s_and_b32 s59, s59, 15
    s_waitcnt lgkmcnt(0)
    v_readfirstlane_b32 s49, v38
    v_cmp_ne_u32 vcc, 0, v39
    s_waitcnt vmcnt(0)
    s_mov_b64 exec, 1
    ds_add_u32 v14, v63
    s_mov_b64 exec, -1
L_tb29:
    ds_read_b32 v36, v14
    s_waitcnt lgkmcnt(0)
    v_readfirstlane_b32 s54, v36
    s_nop 0
    s_cmp_lt_u32 s54, 52
    s_cbranch_scc1 L_tb29
    v_add_u32 v7, 0xfffefc00, v7
    v_add_u32 v8, 0xfffefc00, v8
    v_add_u32 v9, 0xfffefc00, v9
    ds_read_b64_tr_b16 v[208:209], v7 offset:0
    ds_read_b64_tr_b16 v[210:211], v7 offset:6144
    ds_read_b64_tr_b16 v[212:213], v8 offset:0
    ds_read_b64_tr_b16 v[214:215], v8 offset:6144
    ds_read_b64_tr_b16 v[216:217], v9 offset:0
    ds_read_b64_tr_b16 v[218:219], v9 offset:6144
    ds_read_b64_tr_b16 v[220:221], v7 offset:12288
    ds_read_b64_tr_b16 v[222:223], v7 offset:18432
    ds_read_b64_tr_b16 v[224:225], v8 offset:12288
    ds_read_b64_tr_b16 v[226:227], v8 offset:18432
    ds_read_b64_tr_b16 v[228:229], v9 offset:12288
    ds_read_b64_tr_b16 v[230:231], v9 offset:18432
    ds_read_b64_tr_b16 v[232:233], v7 offset:24576
    ds_read_b64_tr_b16 v[234:235], v7 offset:30720
    ds_read_b64_tr_b16 v[236:237], v8 offset:24576
    ds_read_b64_tr_b16 v[238:239], v8 offset:30720
    ds_read_b64_tr_b16 v[240:241], v9 offset:24576
    ds_read_b64_tr_b16 v[242:243], v9 offset:30720
    ds_read_b64_tr_b16 v[244:245], v7 offset:36864
    ds_read_b64_tr_b16 v[246:247], v7 offset:43008
    ds_read_b64_tr_b16 v[248:249], v8 offset:36864
    ds_read_b64_tr_b16 v[250:251], v8 offset:43008
    ds_read_b64_tr_b16 v[252:253], v9 offset:36864
    ds_read_b64_tr_b16 v[254:255], v9 offset:43008
    s_waitcnt lgkmcnt(0)
    s_mov_b64 exec, 1
    ds_add_u32 v14, v63
    s_mov_b64 exec, -1
    v_mfma_f32_16x16x32_bf16 v[48:51], v[16:19], v[208:211], v[48:51]
    v_mfma_f32_16x16x32_bf16 v[52:55], v[16:19], v[212:215], v[52:55]
    v_mfma_f32_16x16x32_bf16 v[56:59], v[16:19], v[216:219], v[56:59]
    v_mfma_f32_16x16x32_bf16 v[48:51], v[16:19], v[220:223], v[48:51]
    v_mfma_f32_16x16x32_bf16 v[52:55], v[16:19], v[224:227], v[52:55]
    v_mfma_f32_16x16x32_bf16 v[56:59], v[16:19], v[228:231], v[56:59]
    v_mfma_f32_16x16x32_bf16 v[48:51], v[16:19], v[232:235], v[48:51]
    v_mfma_f32_16x16x32_bf16 v[52:55], v[16:19], v[236:239], v[52:55]
    v_mfma_f32_16x16x32_bf16 v[56:59], v[16:19], v[240:243], v[56:59]
    v_mfma_f32_16x16x32_bf16 v[48:51], v[16:19], v[244:247], v[48:51]
    v_mfma_f32_16x16x32_bf16 v[52:55], v[16:19], v[248:251], v[52:55]
    v_mfma_f32_16x16x32_bf16 v[56:59], v[16:19], v[252:255], v[56:59]
    s_nop 5
    v_cvt_pk_bf16_f32 v36, v48, 0
    v_lshlrev_b32 v37, 16, v36
    v_sub_f32 v37, v48, v37
    v_cvt_pk_bf16_f32 v37, v48, v37
    v_lshl_or_b32 v38, v60, 16, v60
    v_cndmask_b32 v37, 0, v37, s[64:65]
    v_cndmask_b32 v4, v37, v38, s[62:63]
    v_cndmask_b32 v5, 0, v36, s[64:65]
    v_cvt_pk_bf16_f32 v36, v52, 0
    v_lshlrev_b32 v37, 16, v36
    v_sub_f32 v37, v52, v37
    v_cvt_pk_bf16_f32 v37, v52, v37
    v_lshl_or_b32 v38, v61, 16, v61
    v_cndmask_b32 v37, 0, v37, s[64:65]
    v_cndmask_b32 v6, v37, v38, s[62:63]
    v_cndmask_b32 v7, 0, v36, s[64:65]
    v_cvt_pk_bf16_f32 v36, v56, 0
    v_lshlrev_b32 v37, 16, v36
    v_sub_f32 v37, v56, v37
    v_cvt_pk_bf16_f32 v37, v56, v37
    v_lshl_or_b32 v38, v62, 16, v62
    v_cndmask_b32 v37, 0, v37, s[64:65]
    v_cndmask_b32 v8, v37, v38, s[62:63]
    v_cndmask_b32 v9, 0, v36, s[64:65]
    v_mov_b32 v58, 479744
    v_mov_b32 v59, s49
    s_lshl2_add_u32 s55, s67, s48
    s_branch L_pg30
L_slow48:
    buffer_store_dword v59, v58, s[24:27], s55 offen sc1
    s_branch L_join49
L_slow52:
    buffer_store_dword v59, v58, s[24:27], s55 offen offset:128 sc1
    s_branch L_join53
L_nolead58x:
    v_mov_b32 v24, 520192
    s_mov_b64 exec, 1
    buffer_load_dword v26, v24, s[24:27], 0 offen sc1
    s_mov_b32 s52, 1664525
    v_mov_b32 v27, 1
    s_waitcnt vmcnt(0)
    v_mul_lo_u32 v26, v26, s52
    v_add_u32 v26, 1013904223, v26
    buffer_store_dwordx2 v[26:27], v2, s[40:43], 0 offen sc1
    buffer_store_dword v26, v24, s[24:27], 0 offen sc1
    s_mov_b64 exec, -1
    s_branch L_nolead58
L_np66x:
    s_add_u32 s68, s68, 1
    s_cmp_gt_u32 s68, 200000
    s_cbranch_scc1 L_npd67
    buffer_load_dwordx2 v[20:21], v2, s[40:43], 0 offen sc1
    s_waitcnt vmcnt(0)
    s_branch L_np66
L_xp75x:
    s_add_u32 s68, s68, 1
    s_cmp_gt_u32 s68, 200000
    s_cbranch_scc1 L_xpd76
    buffer_load_dword v19, v17, s[24:27], 0 offen sc1
    s_waitcnt vmcnt(0)
    s_branch L_xp75
L_slow77:
    buffer_store_dword v20, v2, s[24:27], s30 offen offset:128 sc1
    s_branch L_join78
L_slow83:
    buffer_store_dword v20, v2, s[24:27], s30 offen sc1
    s_branch L_join84
L_slow87:
    buffer_store_dword v20, v2, s[24:27], s30 offen sc1
    s_branch L_join88
L_slow90:
    buffer_store_dword v20, v2, s[24:27], s30 offen sc1
    s_branch L_join91
L_slow96:
    buffer_store_dword v20, v2, s[24:27], s30 offen offset:256 sc1
    s_branch L_join97
L_rdy36x:
    s_sleep 1
    ds_read_b32 v52, v2 offset:268
    s_waitcnt lgkmcnt(0)
    s_branch L_rdy36
L_rdy43x:
    s_sleep 1
    ds_read_b32 v52, v2 offset:524
    s_waitcnt lgkmcnt(0)
    s_branch L_rdy43
L_rdy46x:
    s_sleep 1
    ds_read_b32 v52, v2 offset:780
    s_waitcnt lgkmcnt(0)
    s_branch L_rdy46
.p2align 12
L_pg30:
L_rdy0:
    s_sleep 1
    ds_read_b32 v52, v2 offset:12
    s_waitcnt lgkmcnt(0)
    v_readfirstlane_b32 s52, v52
    s_nop 0
    s_cmp_eq_u32 s52, 0
    s_cbranch_scc1 L_rdy0
    s_setprio 2
L_at_T0_31:
    ds_read_b128 v[12:15], v1 offset:0
    ds_read_b128 v[16:19], v1 offset:1024
    ds_read_b128 v[20:23], v1 offset:2048
    s_waitcnt lgkmcnt(2)
    v_mfma_f32_16x16x32_bf16 v[24:27], v[64:67], v[12:15], 0
    ds_read_b128 v[60:63], v1 offset:3072
    v_mfma_f32_16x16x32_bf16 v[28:31], v[68:71], v[12:15], 0
    v_mfma_f32_16x16x32_bf16 v[32:35], v[72:75], v[12:15], 0
    s_waitcnt lgkmcnt(2)
    v_mfma_f32_16x16x32_bf16 v[24:27], v[76:79], v[16:19], v[24:27]
    ds_read_b128 v[12:15], v1 offset:4096
    v_mfma_f32_16x16x32_bf16 v[28:31], v[80:83], v[16:19], v[28:31]
    v_mfma_f32_16x16x32_bf16 v[32:35], v[84:87], v[16:19], v[32:35]
    s_waitcnt lgkmcnt(2)
    v_mfma_f32_16x16x32_bf16 v[24:27], v[88:91], v[20:23], v[24:27]
    ds_read_b128 v[16:19], v1 offset:5120
    v_mfma_f32_16x16x32_bf16 v[28:31], v[92:95], v[20:23], v[28:31]
    v_mfma_f32_16x16x32_bf16 v[32:35], v[96:99], v[20:23], v[32:35]
    s_waitcnt lgkmcnt(2)
    v_mfma_f32_16x16x32_bf16 v[24:27], v[100:103], v[60:63], v[24:27]
    ds_read_b128 v[20:23], v1 offset:6144
    v_mfma_f32_16x16x32_bf16 v[28:31], v[104:107], v[60:63], v[28:31]
    v_mfma_f32_16x16x32_bf16 v[32:35], v[108:111], v[60:63], v[32:35]
    s_waitcnt lgkmcnt(2)
L_at_t0i4_32:
    v_mfma_f32_16x16x32_bf16 v[24:27], v[112:115], v[12:15], v[24:27]
    ds_read_b128 v[60:63], v1 offset:7168
    v_mfma_f32_16x16x32_bf16 v[28:31], v[116:119], v[12:15], v[28:31]
    v_mfma_f32_16x16x32_bf16 v[32:35], v[120:123], v[12:15], v[32:35]
    s_waitcnt lgkmcnt(2)
    v_mfma_f32_16x16x32_bf16 v[24:27], v[124:127], v[16:19], v[24:27]
    ds_read_b128 v[12:15], v1 offset:8192
    v_mfma_f32_16x16x32_bf16 v[28:31], v[128:131], v[16:19], v[28:31]
    v_mfma_f32_16x16x32_bf16 v[32:35], v[132:135], v[16:19], v[32:35]
    s_waitcnt lgkmcnt(2)
    v_mfma_f32_16x16x32_bf16 v[24:27], v[136:139], v[20:23], v[24:27]
    ds_read_b128 v[16:19], v1 offset:9216
    v_mfma_f32_16x16x32_bf16 v[28:31], v[140:143], v[20:23], v[28:31]
    v_mfma_f32_16x16x32_bf16 v[32:35], v[144:147], v[20:23], v[32:35]
    s_waitcnt lgkmcnt(2)
    v_mfma_f32_16x16x32_bf16 v[24:27], v[148:151], v[60:63], v[24:27]
    ds_read_b128 v[20:23], v1 offset:10240
    v_mfma_f32_16x16x32_bf16 v[28:31], v[152:155], v[60:63], v[28:31]
    v_mfma_f32_16x16x32_bf16 v[32:35], v[156:159], v[60:63], v[32:35]
    s_waitcnt lgkmcnt(2)
L_at_t0i8_33:
    v_mfma_f32_16x16x32_bf16 v[24:27], v[160:163], v[12:15], v[24:27]
    ds_read_b128 v[60:63], v1 offset:11264
    v_mfma_f32_16x16x32_bf16 v[28:31], v[164:167], v[12:15], v[28:31]
    v_mfma_f32_16x16x32_bf16 v[32:35], v[168:171], v[12:15], v[32:35]
    s_waitcnt lgkmcnt(2)
    v_mfma_f32_16x16x32_bf16 v[24:27], v[172:175], v[16:19], v[24:27]
    ds_read_b128 v[12:15], v1 offset:12288
    v_mfma_f32_16x16x32_bf16 v[28:31], v[176:179], v[16:19], v[28:31]
    v_mfma_f32_16x16x32_bf16 v[32:35], v[180:183], v[16:19], v[32:35]
    s_waitcnt lgkmcnt(2)
L_at_t0i10_34:
    v_mfma_f32_16x16x32_bf16 v[24:27], v[184:187], v[20:23], v[24:27]
    ds_read_b128 v[16:19], v1 offset:13312
    v_mfma_f32_16x16x32_bf16 v[28:31], v[188:191], v[20:23], v[28:31]
    ds_read_b32 v52, v2 offset:268
    v_mfma_f32_16x16x32_bf16 v[32:35], v[192:195], v[20:23], v[32:35]
    s_waitcnt lgkmcnt(3)
    v_mfma_f32_16x16x32_bf16 v[24:27], v[196:199], v[60:63], v[24:27]
    ds_read_b128 v[20:23], v1 offset:14336
    v_mfma_f32_16x16x32_bf16 v[28:31], v[200:203], v[60:63], v[28:31]
    v_mfma_f32_16x16x32_bf16 v[32:35], v[204:207], v[60:63], v[32:35]
    s_waitcnt lgkmcnt(3)
L_at_t0i12_35:
    v_mfma_f32_16x16x32_bf16 v[24:27], v[208:211], v[12:15], v[24:27]
    ds_read_b128 v[60:63], v1 offset:15360
    v_mfma_f32_16x16x32_bf16 v[28:31], v[212:215], v[12:15], v[28:31]
    v_mfma_f32_16x16x32_bf16 v[32:35], v[216:219], v[12:15], v[32:35]
    s_waitcnt lgkmcnt(3)
    v_mfma_f32_16x16x32_bf16 v[24:27], v[220:223], v[16:19], v[24:27]
    s_waitcnt lgkmcnt(2)
L_rdy36:
    v_readfirstlane_b32 s52, v52
    s_nop 0
    s_cmp_eq_u32 s52, 0
    s_cbranch_scc1 L_rdy36x
    ds_read_b128 v[12:15], v1 offset:16384
    v_mfma_f32_16x16x32_bf16 v[28:31], v[224:227], v[16:19], v[28:31]
    ds_read_b64 v[52:53], v3 offset:0
    v_mfma_f32_16x16x32_bf16 v[32:35], v[228:231], v[16:19], v[32:35]
    s_waitcnt lgkmcnt(3)
L_at_t0i14_37:
    v_mfma_f32_16x16x32_bf16 v[24:27], v[232:235], v[20:23], v[24:27]
    ds_read_b128 v[16:19], v1 offset:17408
    v_mfma_f32_16x16x32_bf16 v[28:31], v[236:239], v[20:23], v[28:31]
    v_mfma_f32_16x16x32_bf16 v[32:35], v[240:243], v[20:23], v[32:35]
    s_waitcnt lgkmcnt(3)
    v_mfma_f32_16x16x32_bf16 v[24:27], v[244:247], v[60:63], v[24:27]
    ds_read_b128 v[20:23], v1 offset:18432
    v_mfma_f32_16x16x32_bf16 v[28:31], v[248:251], v[60:63], v[28:31]
    v_mfma_f32_16x16x32_bf16 v[32:35], v[252:255], v[60:63], v[32:35]
    s_waitcnt lgkmcnt(2)
L_at_rt0_38:
    v_mfma_f32_16x16x16_bf16 v[24:27], v[4:5], v[52:53], v[24:27]
    ds_read_b128 v[48:51], v2 offset:0
    v_mfma_f32_16x16x16_bf16 v[28:31], v[6:7], v[52:53], v[28:31]
    v_mfma_f32_16x16x16_bf16 v[32:35], v[8:9], v[52:53], v[32:35]
    v_mfma_f32_16x16x32_bf16 v[36:39], v[64:67], v[12:15], 0
    ds_read_b128 v[60:63], v1 offset:19456
    v_mfma_f32_16x16x32_bf16 v[40:43], v[68:71], v[12:15], 0
    v_mfma_f32_16x16x32_bf16 v[44:47], v[72:75], v[12:15], 0
    s_waitcnt lgkmcnt(1)
    v_mul_f32 v54, v24, v24
    v_mul_f32 v55, v25, v25
    v_fma_f32 v54, v54, v49, v48
    v_mfma_f32_16x16x32_bf16 v[36:39], v[76:79], v[16:19], v[36:39]
    ds_read_b128 v[12:15], v1 offset:20480
    v_fma_f32 v55, v55, v49, v48
    v_mul_f32 v54, v54, v24
    v_mul_f32 v55, v55, v25
    v_mfma_f32_16x16x32_bf16 v[40:43], v[80:83], v[16:19], v[40:43]
    v_exp_f32 v54, v54
    v_mfma_f32_16x16x32_bf16 v[44:47], v[84:87], v[16:19], v[44:47]
    v_exp_f32 v55, v55
    v_fma_f32 v54, v54, v50, v50
    v_mfma_f32_16x16x32_bf16 v[36:39], v[88:91], v[20:23], v[36:39]
    ds_read_b128 v[16:19], v1 offset:21504
    v_fma_f32 v55, v55, v50, v50
    v_rcp_f32 v54, v54
    v_mfma_f32_16x16x32_bf16 v[40:43], v[92:95], v[20:23], v[40:43]
    v_rcp_f32 v55, v55
    v_mfma_f32_16x16x32_bf16 v[44:47], v[96:99], v[20:23], v[44:47]
    s_waitcnt lgkmcnt(2)
    v_mul_f32 v54, v54, v24
    v_mul_f32 v55, v55, v25
    v_cvt_pk_bf16_f32 v24, v54, v55
    v_mfma_f32_16x16x32_bf16 v[36:39], v[100:103], v[60:63], v[36:39]
    ds_read_b128 v[20:23], v1 offset:22528
    v_mul_f32 v56, v26, v26
    v_mul_f32 v57, v27, v27
    v_mfma_f32_16x16x32_bf16 v[40:43], v[104:107], v[60:63], v[40:43]
    v_fma_f32 v56, v56, v49, v48
    v_fma_f32 v57, v57, v49, v48
    v_mul_f32 v56, v56, v26
    v_mfma_f32_16x16x32_bf16 v[44:47], v[108:111], v[60:63], v[44:47]
    s_waitcnt lgkmcnt(2)
    v_mul_f32 v57, v57, v27
    v_exp_f32 v56, v56
L_at_t1i4_39:
    v_mfma_f32_16x16x32_bf16 v[36:39], v[112:115], v[12:15], v[36:39]
    ds_read_b128 v[60:63], v1 offset:23552
    v_exp_f32 v57, v57
    v_mfma_f32_16x16x32_bf16 v[40:43], v[116:119], v[12:15], v[40:43]
    v_fma_f32 v56, v56, v50, v50
    v_fma_f32 v57, v57, v50, v50
    v_rcp_f32 v56, v56
    v_mfma_f32_16x16x32_bf16 v[44:47], v[120:123], v[12:15], v[44:47]
    s_waitcnt lgkmcnt(2)
    v_rcp_f32 v57, v57
    v_mfma_f32_16x16x32_bf16 v[36:39], v[124:127], v[16:19], v[36:39]
    ds_read_b128 v[12:15], v1 offset:24576
    v_mul_f32 v56, v56, v26
    v_mul_f32 v57, v57, v27
    v_mfma_f32_16x16x32_bf16 v[40:43], v[128:131], v[16:19], v[40:43]
    v_cvt_pk_bf16_f32 v25, v56, v57
    v_mul_f32 v54, v28, v28
    v_mfma_f32_16x16x32_bf16 v[44:47], v[132:135], v[16:19], v[44:47]
    s_waitcnt lgkmcnt(2)
    v_mul_f32 v55, v29, v29
    v_fma_f32 v54, v54, v49, v48
    v_fma_f32 v55, v55, v49, v48
    v_mfma_f32_16x16x32_bf16 v[36:39], v[136:139], v[20:23], v[36:39]
    ds_read_b128 v[16:19], v1 offset:25600
    v_mul_f32 v54, v54, v28
    v_mul_f32 v55, v55, v29
    v_exp_f32 v54, v54
    v_mfma_f32_16x16x32_bf16 v[40:43], v[140:143], v[20:23], v[40:43]
    v_exp_f32 v55, v55
    v_mfma_f32_16x16x32_bf16 v[44:47], v[144:147], v[20:23], v[44:47]
    s_waitcnt lgkmcnt(2)
    v_fma_f32 v54, v54, v50, v50
    v_fma_f32 v55, v55, v50, v50
    v_mfma_f32_16x16x32_bf16 v[36:39], v[148:151], v[60:63], v[36:39]
    ds_read_b128 v[20:23], v1 offset:26624
    v_rcp_f32 v54, v54
    v_mfma_f32_16x16x32_bf16 v[40:43], v[152:155], v[60:63], v[40:43]
    v_rcp_f32 v55, v55
    v_mul_f32 v54, v54, v28
    v_mfma_f32_16x16x32_bf16 v[44:47], v[156:159], v[60:63], v[44:47]
    s_waitcnt lgkmcnt(2)
    v_mul_f32 v55, v55, v29
    v_cvt_pk_bf16_f32 v26, v54, v55
L_at_t1i8_40:
    v_mfma_f32_16x16x32_bf16 v[36:39], v[160:163], v[12:15], v[36:39]
    ds_read_b128 v[60:63], v1 offset:27648
    v_mul_f32 v56, v30, v30
    v_mul_f32 v57, v31, v31
    v_fma_f32 v56, v56, v49, v48
    v_mfma_f32_16x16x32_bf16 v[40:43], v[164:167], v[12:15], v[40:43]
    v_fma_f32 v57, v57, v49, v48
    v_mul_f32 v56, v56, v30
    v_mul_f32 v57, v57, v31
    v_mfma_f32_16x16x32_bf16 v[44:47], v[168:171], v[12:15], v[44:47]
    s_waitcnt lgkmcnt(2)
    v_exp_f32 v56, v56
    v_mfma_f32_16x16x32_bf16 v[36:39], v[172:175], v[16:19], v[36:39]
    ds_read_b128 v[12:15], v1 offset:28672
    v_exp_f32 v57, v57
    v_fma_f32 v56, v56, v50, v50
    v_mfma_f32_16x16x32_bf16 v[40:43], v[176:179], v[16:19], v[40:43]
    v_fma_f32 v57, v57, v50, v50
    v_rcp_f32 v56, v56
    v_mfma_f32_16x16x32_bf16 v[44:47], v[180:183], v[16:19], v[44:47]
    s_waitcnt lgkmcnt(2)
    v_rcp_f32 v57, v57
L_at_t1i10_41:
    v_mfma_f32_16x16x32_bf16 v[36:39], v[184:187], v[20:23], v[36:39]
    ds_read_b128 v[16:19], v1 offset:29696
    v_mul_f32 v56, v56, v30
    v_mul_f32 v57, v57, v31
    v_cvt_pk_bf16_f32 v27, v56, v57
    v_mfma_f32_16x16x32_bf16 v[40:43], v[188:191], v[20:23], v[40:43]
    ds_read_b32 v52, v2 offset:524
    buffer_store_dwordx4 v[24:27], v10, s[24:27], 0 offen offset:0 sc1
    v_mul_f32 v54, v32, v32
    v_mul_f32 v55, v33, v33
    v_mfma_f32_16x16x32_bf16 v[44:47], v[192:195], v[20:23], v[44:47]
    s_waitcnt lgkmcnt(3)
    v_fma_f32 v54, v54, v49, v48
    v_fma_f32 v55, v55, v49, v48
    v_mul_f32 v54, v54, v32
    v_mfma_f32_16x16x32_bf16 v[36:39], v[196:199], v[60:63], v[36:39]
    ds_read_b128 v[20:23], v1 offset:30720
    v_mul_f32 v55, v55, v33
    v_exp_f32 v54, v54
    v_mfma_f32_16x16x32_bf16 v[40:43], v[200:203], v[60:63], v[40:43]
    v_exp_f32 v55, v55
    v_mfma_f32_16x16x32_bf16 v[44:47], v[204:207], v[60:63], v[44:47]
    s_waitcnt lgkmcnt(3)
    v_fma_f32 v54, v54, v50, v50
    v_fma_f32 v55, v55, v50, v50
    v_rcp_f32 v54, v54
L_at_t1i12_42:
    v_mfma_f32_16x16x32_bf16 v[36:39], v[208:211], v[12:15], v[36:39]
    ds_read_b128 v[60:63], v1 offset:31744
    v_rcp_f32 v55, v55
    v_mfma_f32_16x16x32_bf16 v[40:43], v[212:215], v[12:15], v[40:43]
    v_mul_f32 v54, v54, v32
    v_mul_f32 v55, v55, v33
    v_mfma_f32_16x16x32_bf16 v[44:47], v[216:219], v[12:15], v[44:47]
    s_waitcnt lgkmcnt(3)
    v_cvt_pk_bf16_f32 v32, v54, v55
    v_mul_f32 v56, v34, v34
    v_mfma_f32_16x16x32_bf16 v[36:39], v[220:223], v[16:19], v[36:39]
    s_waitcnt lgkmcnt(2)
L_rdy43:
    v_readfirstlane_b32 s52, v52
    s_nop 0
    s_cmp_eq_u32 s52, 0
    s_cbranch_scc1 L_rdy43x
    ds_read_b128 v[12:15], v1 offset:32768
    v_mul_f32 v57, v35, v35
    v_fma_f32 v56, v56, v49, v48
    v_fma_f32 v57, v57, v49, v48
    v_mfma_f32_16x16x32_bf16 v[40:43], v[224:227], v[16:19], v[40:43]
    ds_read_b64 v[52:53], v3 offset:512
    v_mul_f32 v56, v56, v34
    v_mul_f32 v57, v57, v35
    v_exp_f32 v56, v56
    v_mfma_f32_16x16x32_bf16 v[44:47], v[228:231], v[16:19], v[44:47]
    s_waitcnt lgkmcnt(3)
    v_exp_f32 v57, v57
L_at_t1i14_44:
    v_mfma_f32_16x16x32_bf16 v[36:39], v[232:235], v[20:23], v[36:39]
    ds_read_b128 v[16:19], v1 offset:33792
    v_fma_f32 v56, v56, v50, v50
    v_fma_f32 v57, v57, v50, v50
    v_mfma_f32_16x16x32_bf16 v[40:43], v[236:239], v[20:23], v[40:43]
    v_rcp_f32 v56, v56
    v_mfma_f32_16x16x32_bf16 v[44:47], v[240:243], v[20:23], v[44:47]
    s_waitcnt lgkmcnt(3)
    v_rcp_f32 v57, v57
    v_mul_f32 v56, v56, v34
    v_mfma_f32_16x16x32_bf16 v[36:39], v[244:247], v[60:63], v[36:39]
    ds_read_b128 v[20:23], v1 offset:34816
    v_mul_f32 v57, v57, v35
    v_cvt_pk_bf16_f32 v33, v56, v57
    v_mfma_f32_16x16x32_bf16 v[40:43], v[248:251], v[60:63], v[40:43]
    buffer_store_dwordx2 v[32:33], v11, s[24:27], 0 offen offset:0 sc1
    v_mfma_f32_16x16x32_bf16 v[44:47], v[252:255], v[60:63], v[44:47]
    s_waitcnt lgkmcnt(2)
L_at_rt1_45:
    v_mfma_f32_16x16x16_bf16 v[36:39], v[4:5], v[52:53], v[36:39]
    ds_read_b128 v[48:51], v2 offset:256
    v_mfma_f32_16x16x16_bf16 v[40:43], v[6:7], v[52:53], v[40:43]
    v_mfma_f32_16x16x16_bf16 v[44:47], v[8:9], v[52:53], v[44:47]
    v_mfma_f32_16x16x32_bf16 v[24:27], v[64:67], v[12:15], 0
    ds_read_b128 v[60:63], v1 offset:35840
    v_mfma_f32_16x16x32_bf16 v[28:31], v[68:71], v[12:15], 0
    v_mfma_f32_16x16x32_bf16 v[32:35], v[72:75], v[12:15], 0
    s_waitcnt lgkmcnt(1)
    v_mul_f32 v54, v36, v36
    v_mul_f32 v55, v37, v37
    v_fma_f32 v54, v54, v49, v48
    v_mfma_f32_16x16x32_bf16 v[24:27], v[76:79], v[16:19], v[24:27]
    ds_read_b128 v[12:15], v1 offset:36864
    v_fma_f32 v55, v55, v49, v48
    v_mul_f32 v54, v54, v36
    v_mul_f32 v55, v55, v37
    v_mfma_f32_16x16x32_bf16 v[28:31], v[80:83], v[16:19], v[28:31]
    v_exp_f32 v54, v54
    v_mfma_f32_16x16x32_bf16 v[32:35], v[84:87], v[16:19], v[32:35]
    v_exp_f32 v55, v55
    v_fma_f32 v54, v54, v50, v50
    v_mfma_f32_16x16x32_bf16 v[24:27], v[88:91], v[20:23], v[24:27]
    ds_read_b128 v[16:19], v1 offset:37888
    v_fma_f32 v55, v55, v50, v50
    v_rcp_f32 v54, v54
    v_mfma_f32_16x16x32_bf16 v[28:31], v[92:95], v[20:23], v[28:31]
    v_rcp_f32 v55, v55
    v_mfma_f32_16x16x32_bf16 v[32:35], v[96:99], v[20:23], v[32:35]
    s_waitcnt lgkmcnt(2)
    v_mul_f32 v54, v54, v36
    v_mul_f32 v55, v55, v37
    v_cvt_pk_bf16_f32 v36, v54, v55
    v_mfma_f32_16x16x32_bf16 v[24:27], v[100:103], v[60:63], v[24:27]
    ds_read_b128 v[20:23], v1 offset:38912
    v_mul_f32 v56, v38, v38
    v_mul_f32 v57, v39, v39
    v_mfma_f32_16x16x32_bf16 v[28:31], v[104:107], v[60:63], v[28:31]
    v_fma_f32 v56, v56, v49, v48
    v_fma_f32 v57, v57, v49, v48
    v_mul_f32 v56, v56, v38
    v_mfma_f32_16x16x32_bf16 v[32:35], v[108:111], v[60:63], v[32:35]
    s_waitcnt lgkmcnt(2)
    v_mul_f32 v57, v57, v39
    v_exp_f32 v56, v56
    v_mfma_f32_16x16x32_bf16 v[24:27], v[112:115], v[12:15], v[24:27]
    ds_read_b128 v[60:63], v1 offset:39936
    v_exp_f32 v57, v57
    v_mfma_f32_16x16x32_bf16 v[28:31], v[116:119], v[12:15], v[28:31]
    v_fma_f32 v56, v56, v50, v50
    v_fma_f32 v57, v57, v50, v50
    v_rcp_f32 v56, v56
    v_mfma_f32_16x16x32_bf16 v[32:35], v[120:123], v[12:15], v[32:35]
    s_waitcnt lgkmcnt(2)
    v_rcp_f32 v57, v57
    v_mfma_f32_16x16x32_bf16 v[24:27], v[124:127], v[16:19], v[24:27]
    ds_read_b128 v[12:15], v1 offset:40960
    v_mul_f32 v56, v56, v38
    v_mul_f32 v57, v57, v39
    v_mfma_f32_16x16x32_bf16 v[28:31], v[128:131], v[16:19], v[28:31]
    v_cvt_pk_bf16_f32 v37, v56, v57
    v_mul_f32 v54, v40, v40
    v_mfma_f32_16x16x32_bf16 v[32:35], v[132:135], v[16:19], v[32:35]
    s_waitcnt lgkmcnt(2)
    v_mul_f32 v55, v41, v41
    v_fma_f32 v54, v54, v49, v48
    v_fma_f32 v55, v55, v49, v48
    v_mfma_f32_16x16x32_bf16 v[24:27], v[136:139], v[20:23], v[24:27]
    ds_read_b128 v[16:19], v1 offset:41984
    v_mul_f32 v54, v54, v40
    v_mul_f32 v55, v55, v41
    v_exp_f32 v54, v54
    v_mfma_f32_16x16x32_bf16 v[28:31], v[140:143], v[20:23], v[28:31]
    v_exp_f32 v55, v55
    v_mfma_f32_16x16x32_bf16 v[32:35], v[144:147], v[20:23], v[32:35]
    s_waitcnt lgkmcnt(2)
    v_fma_f32 v54, v54, v50, v50
    v_fma_f32 v55, v55, v50, v50
    v_mfma_f32_16x16x32_bf16 v[24:27], v[148:151], v[60:63], v[24:27]
    ds_read_b128 v[20:23], v1 offset:43008
    v_rcp_f32 v54, v54
    v_mfma_f32_16x16x32_bf16 v[28:31], v[152:155], v[60:63], v[28:31]
    v_rcp_f32 v55, v55
    v_mul_f32 v54, v54, v40
    v_mfma_f32_16x16x32_bf16 v[32:35], v[156:159], v[60:63], v[32:35]
    s_waitcnt lgkmcnt(2)
    v_mul_f32 v55, v55, v41
    v_cvt_pk_bf16_f32 v38, v54, v55
    v_mfma_f32_16x16x32_bf16 v[24:27], v[160:163], v[12:15], v[24:27]
    ds_read_b128 v[60:63], v1 offset:44032
    v_mul_f32 v56, v42, v42
    v_mul_f32 v57, v43, v43
    v_fma_f32 v56, v56, v49, v48
    v_mfma_f32_16x16x32_bf16 v[28:31], v[164:167], v[12:15], v[28:31]
    v_fma_f32 v57, v57, v49, v48
    v_mul_f32 v56, v56, v42
    v_mul_f32 v57, v57, v43
    v_mfma_f32_16x16x32_bf16 v[32:35], v[168:171], v[12:15], v[32:35]
    s_waitcnt lgkmcnt(2)
    v_exp_f32 v56, v56
    v_mfma_f32_16x16x32_bf16 v[24:27], v[172:175], v[16:19], v[24:27]
    ds_read_b128 v[12:15], v1 offset:45056
    v_exp_f32 v57, v57
    v_fma_f32 v56, v56, v50, v50
    v_mfma_f32_16x16x32_bf16 v[28:31], v[176:179], v[16:19], v[28:31]
    v_fma_f32 v57, v57, v50, v50
    v_rcp_f32 v56, v56
    v_mfma_f32_16x16x32_bf16 v[32:35], v[180:183], v[16:19], v[32:35]
    s_waitcnt lgkmcnt(2)
    v_rcp_f32 v57, v57
    v_mfma_f32_16x16x32_bf16 v[24:27], v[184:187], v[20:23], v[24:27]
    ds_read_b128 v[16:19], v1 offset:46080
    v_mul_f32 v56, v56, v42
    v_mul_f32 v57, v57, v43
    v_cvt_pk_bf16_f32 v39, v56, v57
    v_mfma_f32_16x16x32_bf16 v[28:31], v[188:191], v[20:23], v[28:31]
    ds_read_b32 v52, v2 offset:780
    buffer_store_dwordx4 v[36:39], v10, s[24:27], 0 offen offset:256 sc1
    v_mul_f32 v54, v44, v44
    v_mul_f32 v55, v45, v45
    v_mfma_f32_16x16x32_bf16 v[32:35], v[192:195], v[20:23], v[32:35]
    s_waitcnt lgkmcnt(3)
    v_fma_f32 v54, v54, v49, v48
    v_fma_f32 v55, v55, v49, v48
    v_mul_f32 v54, v54, v44
    v_mfma_f32_16x16x32_bf16 v[24:27], v[196:199], v[60:63], v[24:27]
    ds_read_b128 v[20:23], v1 offset:47104
    v_mul_f32 v55, v55, v45
    v_exp_f32 v54, v54
    v_mfma_f32_16x16x32_bf16 v[28:31], v[200:203], v[60:63], v[28:31]
    v_exp_f32 v55, v55
    v_mfma_f32_16x16x32_bf16 v[32:35], v[204:207], v[60:63], v[32:35]
    s_waitcnt lgkmcnt(3)
    v_fma_f32 v54, v54, v50, v50
    v_fma_f32 v55, v55, v50, v50
    v_rcp_f32 v54, v54
    v_mfma_f32_16x16x32_bf16 v[24:27], v[208:211], v[12:15], v[24:27]
    ds_read_b128 v[60:63], v1 offset:48128
    v_rcp_f32 v55, v55
    v_mfma_f32_16x16x32_bf16 v[28:31], v[212:215], v[12:15], v[28:31]
    v_mul_f32 v54, v54, v44
    v_mul_f32 v55, v55, v45
    v_mfma_f32_16x16x32_bf16 v[32:35], v[216:219], v[12:15], v[32:35]
    s_waitcnt lgkmcnt(3)
    v_cvt_pk_bf16_f32 v44, v54, v55
    v_mul_f32 v56, v46, v46
    v_mfma_f32_16x16x32_bf16 v[24:27], v[220:223], v[16:19], v[24:27]
    s_waitcnt lgkmcnt(2)
L_rdy46:
    v_readfirstlane_b32 s52, v52
    s_nop 0
    s_cmp_eq_u32 s52, 0
    s_cbranch_scc1 L_rdy46x
    ds_read_b128 v[12:15], v1 offset:49152
    v_mul_f32 v57, v47, v47
    v_fma_f32 v56, v56, v49, v48
    v_fma_f32 v57, v57, v49, v48
    v_mfma_f32_16x16x32_bf16 v[28:31], v[224:227], v[16:19], v[28:31]
    ds_read_b64 v[52:53], v3 offset:1024
    v_mul_f32 v56, v56, v46
    v_mul_f32 v57, v57, v47
    v_exp_f32 v56, v56
    v_mfma_f32_16x16x32_bf16 v[32:35], v[228:231], v[16:19], v[32:35]
    s_waitcnt lgkmcnt(3)
    v_exp_f32 v57, v57
    v_mfma_f32_16x16x32_bf16 v[24:27], v[232:235], v[20:23], v[24:27]
    ds_read_b128 v[16:19], v1 offset:50176
    v_fma_f32 v56, v56, v50, v50
    v_fma_f32 v57, v57, v50, v50
    v_mfma_f32_16x16x32_bf16 v[28:31], v[236:239], v[20:23], v[28:31]
    v_rcp_f32 v56, v56
    v_mfma_f32_16x16x32_bf16 v[32:35], v[240:243], v[20:23], v[32:35]
    s_waitcnt lgkmcnt(3)
    v_rcp_f32 v57, v57
    v_mul_f32 v56, v56, v46
    v_mfma_f32_16x16x32_bf16 v[24:27], v[244:247], v[60:63], v[24:27]
    ds_read_b128 v[20:23], v1 offset:51200
    v_mul_f32 v57, v57, v47
    v_cvt_pk_bf16_f32 v45, v56, v57
    v_mfma_f32_16x16x32_bf16 v[28:31], v[248:251], v[60:63], v[28:31]
    buffer_store_dwordx2 v[44:45], v11, s[24:27], 0 offen offset:256 sc1
    v_mfma_f32_16x16x32_bf16 v[32:35], v[252:255], v[60:63], v[32:35]
    s_waitcnt lgkmcnt(2)
L_at_rt2_47:
    v_mfma_f32_16x16x16_bf16 v[24:27], v[4:5], v[52:53], v[24:27]
    ds_read_b128 v[48:51], v2 offset:512
    v_mfma_f32_16x16x16_bf16 v[28:31], v[6:7], v[52:53], v[28:31]
    v_mfma_f32_16x16x16_bf16 v[32:35], v[8:9], v[52:53], v[32:35]
    v_mfma_f32_16x16x32_bf16 v[36:39], v[64:67], v[12:15], 0
    ds_read_b128 v[60:63], v1 offset:52224
    v_mfma_f32_16x16x32_bf16 v[40:43], v[68:71], v[12:15], 0
    v_mfma_f32_16x16x32_bf16 v[44:47], v[72:75], v[12:15], 0
    s_waitcnt lgkmcnt(1)
    v_mul_f32 v54, v24, v24
    v_mul_f32 v55, v25, v25
    v_fma_f32 v54, v54, v49, v48
    v_mfma_f32_16x16x32_bf16 v[36:39], v[76:79], v[16:19], v[36:39]
    ds_read_b128 v[12:15], v1 offset:53248
    v_fma_f32 v55, v55, v49, v48
    v_mul_f32 v54, v54, v24
    v_mul_f32 v55, v55, v25
    v_mfma_f32_16x16x32_bf16 v[40:43], v[80:83], v[16:19], v[40:43]
    v_exp_f32 v54, v54
    v_mfma_f32_16x16x32_bf16 v[44:47], v[84:87], v[16:19], v[44:47]
    v_exp_f32 v55, v55
    v_fma_f32 v54, v54, v50, v50
    v_mfma_f32_16x16x32_bf16 v[36:39], v[88:91], v[20:23], v[36:39]
    ds_read_b128 v[16:19], v1 offset:54272
    v_fma_f32 v55, v55, v50, v50
    v_rcp_f32 v54, v54
    v_mfma_f32_16x16x32_bf16 v[40:43], v[92:95], v[20:23], v[40:43]
    v_rcp_f32 v55, v55
    v_mfma_f32_16x16x32_bf16 v[44:47], v[96:99], v[20:23], v[44:47]
    s_waitcnt lgkmcnt(2)
    v_mul_f32 v54, v54, v24
    v_mul_f32 v55, v55, v25
    v_cvt_pk_bf16_f32 v24, v54, v55
    v_mfma_f32_16x16x32_bf16 v[36:39], v[100:103], v[60:63], v[36:39]
    ds_read_b128 v[20:23], v1 offset:55296
    v_mul_f32 v56, v26, v26
    v_mul_f32 v57, v27, v27
    v_mfma_f32_16x16x32_bf16 v[40:43], v[104:107], v[60:63], v[40:43]
    v_fma_f32 v56, v56, v49, v48
    v_fma_f32 v57, v57, v49, v48
    v_mul_f32 v56, v56, v26
    v_mfma_f32_16x16x32_bf16 v[44:47], v[108:111], v[60:63], v[44:47]
    s_waitcnt lgkmcnt(2)
    v_mul_f32 v57, v57, v27
    v_exp_f32 v56, v56
    v_mfma_f32_16x16x32_bf16 v[36:39], v[112:115], v[12:15], v[36:39]
    ds_read_b128 v[60:63], v1 offset:56320
    v_exp_f32 v57, v57
    v_mfma_f32_16x16x32_bf16 v[40:43], v[116:119], v[12:15], v[40:43]
    v_fma_f32 v56, v56, v50, v50
    v_fma_f32 v57, v57, v50, v50
    v_rcp_f32 v56, v56
    v_mfma_f32_16x16x32_bf16 v[44:47], v[120:123], v[12:15], v[44:47]
    s_waitcnt lgkmcnt(2)
    v_rcp_f32 v57, v57
    v_mfma_f32_16x16x32_bf16 v[36:39], v[124:127], v[16:19], v[36:39]
    ds_read_b128 v[12:15], v1 offset:57344
    v_mul_f32 v56, v56, v26
    v_mul_f32 v57, v57, v27
    v_mfma_f32_16x16x32_bf16 v[40:43], v[128:131], v[16:19], v[40:43]
    v_cvt_pk_bf16_f32 v25, v56, v57
    v_mul_f32 v54, v28, v28
    v_mfma_f32_16x16x32_bf16 v[44:47], v[132:135], v[16:19], v[44:47]
    s_waitcnt lgkmcnt(2)
    v_mul_f32 v55, v29, v29
    v_fma_f32 v54, v54, v49, v48
    v_fma_f32 v55, v55, v49, v48
    v_mfma_f32_16x16x32_bf16 v[36:39], v[136:139], v[20:23], v[36:39]
    ds_read_b128 v[16:19], v1 offset:58368
    v_mul_f32 v54, v54, v28
    v_mul_f32 v55, v55, v29
    v_exp_f32 v54, v54
    v_mfma_f32_16x16x32_bf16 v[40:43], v[140:143], v[20:23], v[40:43]
    v_exp_f32 v55, v55
    v_mfma_f32_16x16x32_bf16 v[44:47], v[144:147], v[20:23], v[44:47]
    s_waitcnt lgkmcnt(2)
    v_fma_f32 v54, v54, v50, v50
    v_fma_f32 v55, v55, v50, v50
    v_mfma_f32_16x16x32_bf16 v[36:39], v[148:151], v[60:63], v[36:39]
    ds_read_b128 v[20:23], v1 offset:59392
    v_rcp_f32 v54, v54
    v_mfma_f32_16x16x32_bf16 v[40:43], v[152:155], v[60:63], v[40:43]
    v_rcp_f32 v55, v55
    v_mul_f32 v54, v54, v28
    v_mfma_f32_16x16x32_bf16 v[44:47], v[156:159], v[60:63], v[44:47]
    s_waitcnt lgkmcnt(2)
    v_mul_f32 v55, v55, v29
    v_cvt_pk_bf16_f32 v26, v54, v55
    v_mfma_f32_16x16x32_bf16 v[36:39], v[160:163], v[12:15], v[36:39]
    ds_read_b128 v[60:63], v1 offset:60416
    v_mul_f32 v56, v30, v30
    v_mul_f32 v57, v31, v31
    v_fma_f32 v56, v56, v49, v48
    v_mfma_f32_16x16x32_bf16 v[40:43], v[164:167], v[12:15], v[40:43]
    v_fma_f32 v57, v57, v49, v48
    v_mul_f32 v56, v56, v30
    v_mul_f32 v57, v57, v31
    v_mfma_f32_16x16x32_bf16 v[44:47], v[168:171], v[12:15], v[44:47]
    s_waitcnt lgkmcnt(2)
    v_exp_f32 v56, v56
    v_mfma_f32_16x16x32_bf16 v[36:39], v[172:175], v[16:19], v[36:39]
    ds_read_b128 v[12:15], v1 offset:61440
    v_exp_f32 v57, v57
    v_fma_f32 v56, v56, v50, v50
    v_mfma_f32_16x16x32_bf16 v[40:43], v[176:179], v[16:19], v[40:43]
    s_waitcnt vmcnt(0)
    s_mov_b64 exec, 1
    s_cbranch_vccz L_slow48
    buffer_store_dword v59, v58, s[24:27], s55 offen
L_join49:
    s_mov_b64 exec, -1
    v_fma_f32 v57, v57, v50, v50
    v_rcp_f32 v56, v56
    v_mfma_f32_16x16x32_bf16 v[44:47], v[180:183], v[16:19], v[44:47]
    s_waitcnt lgkmcnt(2)
    v_rcp_f32 v57, v57
    v_mfma_f32_16x16x32_bf16 v[36:39], v[184:187], v[20:23], v[36:39]
    ds_read_b128 v[16:19], v1 offset:62464
    v_mul_f32 v56, v56, v30
    v_mul_f32 v57, v57, v31
    v_cvt_pk_bf16_f32 v27, v56, v57
    v_mfma_f32_16x16x32_bf16 v[40:43], v[188:191], v[20:23], v[40:43]
    v_mul_f32 v54, v32, v32
    v_mul_f32 v55, v33, v33
    v_mfma_f32_16x16x32_bf16 v[44:47], v[192:195], v[20:23], v[44:47]
    s_waitcnt lgkmcnt(2)
    v_fma_f32 v54, v54, v49, v48
    v_fma_f32 v55, v55, v49, v48
    v_mul_f32 v54, v54, v32
    v_mfma_f32_16x16x32_bf16 v[36:39], v[196:199], v[60:63], v[36:39]
    ds_read_b128 v[20:23], v1 offset:63488
    v_mul_f32 v55, v55, v33
    v_exp_f32 v54, v54
    v_mfma_f32_16x16x32_bf16 v[40:43], v[200:203], v[60:63], v[40:43]
    v_exp_f32 v55, v55
    v_mfma_f32_16x16x32_bf16 v[44:47], v[204:207], v[60:63], v[44:47]
    s_waitcnt lgkmcnt(2)
    v_fma_f32 v54, v54, v50, v50
    v_fma_f32 v55, v55, v50, v50
    v_rcp_f32 v54, v54
    v_mfma_f32_16x16x32_bf16 v[36:39], v[208:211], v[12:15], v[36:39]
    ds_read_b128 v[60:63], v1 offset:64512
    v_rcp_f32 v55, v55
    v_mfma_f32_16x16x32_bf16 v[40:43], v[212:215], v[12:15], v[40:43]
    v_mul_f32 v54, v54, v32
    v_mul_f32 v55, v55, v33
    v_mfma_f32_16x16x32_bf16 v[44:47], v[216:219], v[12:15], v[44:47]
    s_waitcnt lgkmcnt(2)
    v_cvt_pk_bf16_f32 v32, v54, v55
    v_mul_f32 v56, v34, v34
    v_mfma_f32_16x16x32_bf16 v[36:39], v[220:223], v[16:19], v[36:39]
    v_mul_f32 v57, v35, v35
    v_fma_f32 v56, v56, v49, v48
    v_fma_f32 v57, v57, v49, v48
    v_mfma_f32_16x16x32_bf16 v[40:43], v[224:227], v[16:19], v[40:43]
    ds_read_b64 v[52:53], v3 offset:1536
    v_mul_f32 v56, v56, v34
    v_mul_f32 v57, v57, v35
    v_exp_f32 v56, v56
    v_mfma_f32_16x16x32_bf16 v[44:47], v[228:231], v[16:19], v[44:47]
    s_waitcnt lgkmcnt(2)
    v_exp_f32 v57, v57
    v_mfma_f32_16x16x32_bf16 v[36:39], v[232:235], v[20:23], v[36:39]
    v_fma_f32 v56, v56, v50, v50
    v_fma_f32 v57, v57, v50, v50
    v_mfma_f32_16x16x32_bf16 v[40:43], v[236:239], v[20:23], v[40:43]
    v_rcp_f32 v56, v56
    v_mfma_f32_16x16x32_bf16 v[44:47], v[240:243], v[20:23], v[44:47]
    s_waitcnt lgkmcnt(1)
    v_rcp_f32 v57, v57
    v_mul_f32 v56, v56, v34
    v_mfma_f32_16x16x32_bf16 v[36:39], v[244:247], v[60:63], v[36:39]
    v_mul_f32 v57, v57, v35
    v_cvt_pk_bf16_f32 v33, v56, v57
    v_mfma_f32_16x16x32_bf16 v[40:43], v[248:251], v[60:63], v[40:43]
    v_mfma_f32_16x16x32_bf16 v[44:47], v[252:255], v[60:63], v[44:47]
    s_waitcnt lgkmcnt(0)
L_at_rt3_50:
    v_mfma_f32_16x16x16_bf16 v[36:39], v[4:5], v[52:53], v[36:39]
    ds_read_b128 v[48:51], v2 offset:768
    v_mfma_f32_16x16x16_bf16 v[40:43], v[6:7], v[52:53], v[40:43]
    v_mfma_f32_16x16x16_bf16 v[44:47], v[8:9], v[52:53], v[44:47]
    s_waitcnt lgkmcnt(0)
    s_nop 3
    v_pk_mul_f32 v[54:55], v[36:37], v[36:37]
    v_pk_mul_f32 v[56:57], v[38:39], v[38:39]
    v_pk_fma_f32 v[54:55], v[54:55], v[48:49], v[48:49] op_sel:[0,1,0] op_sel_hi:[1,1,0]
    v_pk_fma_f32 v[56:57], v[56:57], v[48:49], v[48:49] op_sel:[0,1,0] op_sel_hi:[1,1,0]
    v_pk_mul_f32 v[54:55], v[54:55], v[36:37]
    v_pk_mul_f32 v[56:57], v[56:57], v[38:39]
    v_exp_f32 v54, v54
    v_exp_f32 v56, v56
    v_exp_f32 v55, v55
    v_exp_f32 v57, v57
    v_pk_fma_f32 v[54:55], v[54:55], v[50:51], v[50:51] op_sel:[0,0,0] op_sel_hi:[1,0,0]
    v_pk_fma_f32 v[56:57], v[56:57], v[50:51], v[50:51] op_sel:[0,0,0] op_sel_hi:[1,0,0]
    v_rcp_f32 v54, v54
    v_rcp_f32 v56, v56
    v_rcp_f32 v55, v55
    v_rcp_f32 v57, v57
    v_pk_mul_f32 v[54:55], v[54:55], v[36:37]
    v_pk_mul_f32 v[56:57], v[56:57], v[38:39]
    v_cvt_pk_bf16_f32 v36, v54, v55
    v_cvt_pk_bf16_f32 v37, v56, v57
    v_pk_mul_f32 v[54:55], v[40:41], v[40:41]
    v_pk_mul_f32 v[56:57], v[42:43], v[42:43]
    v_pk_fma_f32 v[54:55], v[54:55], v[48:49], v[48:49] op_sel:[0,1,0] op_sel_hi:[1,1,0]
    v_pk_fma_f32 v[56:57], v[56:57], v[48:49], v[48:49] op_sel:[0,1,0] op_sel_hi:[1,1,0]
    v_pk_mul_f32 v[54:55], v[54:55], v[40:41]
    v_pk_mul_f32 v[56:57], v[56:57], v[42:43]
    v_exp_f32 v54, v54
    v_exp_f32 v56, v56
    v_exp_f32 v55, v55
    v_exp_f32 v57, v57
    v_pk_fma_f32 v[54:55], v[54:55], v[50:51], v[50:51] op_sel:[0,0,0] op_sel_hi:[1,0,0]
    v_pk_fma_f32 v[56:57], v[56:57], v[50:51], v[50:51] op_sel:[0,0,0] op_sel_hi:[1,0,0]
    v_rcp_f32 v54, v54
    v_rcp_f32 v56, v56
    v_rcp_f32 v55, v55
    v_rcp_f32 v57, v57
    v_pk_mul_f32 v[54:55], v[54:55], v[40:41]
    v_pk_mul_f32 v[56:57], v[56:57], v[42:43]
    v_cvt_pk_bf16_f32 v38, v54, v55
    v_cvt_pk_bf16_f32 v39, v56, v57
    buffer_store_dwordx4 v[24:27], v10, s[24:27], s4 offen offset:0 sc1
    buffer_store_dwordx4 v[36:39], v10, s[24:27], s4 offen offset:256 sc1
    v_pk_mul_f32 v[54:55], v[44:45], v[44:45]
    v_pk_mul_f32 v[56:57], v[46:47], v[46:47]
    v_pk_fma_f32 v[54:55], v[54:55], v[48:49], v[48:49] op_sel:[0,1,0] op_sel_hi:[1,1,0]
    v_pk_fma_f32 v[56:57], v[56:57], v[48:49], v[48:49] op_sel:[0,1,0] op_sel_hi:[1,1,0]
    v_pk_mul_f32 v[54:55], v[54:55], v[44:45]
    v_pk_mul_f32 v[56:57], v[56:57], v[46:47]
    v_exp_f32 v54, v54
    v_exp_f32 v56, v56
    v_exp_f32 v55, v55
    v_exp_f32 v57, v57
    v_pk_fma_f32 v[54:55], v[54:55], v[50:51], v[50:51] op_sel:[0,0,0] op_sel_hi:[1,0,0]
    v_pk_fma_f32 v[56:57], v[56:57], v[50:51], v[50:51] op_sel:[0,0,0] op_sel_hi:[1,0,0]
    v_rcp_f32 v54, v54
    v_rcp_f32 v56, v56
    v_rcp_f32 v55, v55
    v_rcp_f32 v57, v57
    v_pk_mul_f32 v[54:55], v[54:55], v[44:45]
    v_pk_mul_f32 v[56:57], v[56:57], v[46:47]
    v_cvt_pk_bf16_f32 v44, v54, v55
    v_cvt_pk_bf16_f32 v45, v56, v57
    buffer_store_dwordx2 v[32:33], v11, s[24:27], s4 offen offset:0 sc1
    buffer_store_dwordx2 v[44:45], v11, s[24:27], s4 offen offset:256 sc1
L_at_s4end_51:
    v_mbcnt_lo_u32_b32 v28, -1, 0
    v_mbcnt_hi_u32_b32 v28, -1, v28
    v_and_b32 v20, 7, v28
    v_lshrrev_b32 v21, 3, v28
    v_lshlrev_b32 v22, 4, v20
    s_lshl_b32 s52, s45, 7
    s_lshl_b32 s53, s44, 16
    s_add_u32 s56, s52, s53
    s_lshl_b32 s53, s46, 13
    s_add_u32 s56, s56, s53
    v_lshl_add_u32 v1, v21, 10, v22
    v_add_u32 v1, s56, v1
    v_lshlrev_b32 v23, 1, v20
    v_xor_b32 v23, v23, v21
    v_lshlrev_b32 v23, 4, v23
    v_lshl_add_u32 v23, v21, 8, v23
    s_lshl_b32 s53, s46, 11
    v_add_u32 v2, s53, v23
    v_xor_b32 v3, 16, v2
    v_add_u32 v4, 126976, v2
    v_add_u32 v5, 126976, v3
    v_lshrrev_b32 v23, 2, v20
    v_lshlrev_b32 v23, 10, v23
    v_lshl_add_u32 v23, v21, 4, v23
    v_and_b32 v21, 1, v20
    v_lshl_add_u32 v23, v21, 9, v23
    v_bfe_u32 v21, v20, 1, 1
    v_lshl_add_u32 v23, v21, 3, v23
    s_lshl_b32 s53, s45, 1
    s_sub_u32 s53, s53, s51
    s_and_b32 s53, s53, 15
    s_lshl_b32 s53, s53, 10
    s_and_b32 s54, s46, 1
    s_lshl_b32 s54, s54, 7
    s_add_u32 s53, s53, s54
    s_lshr_b32 s54, s46, 1
    s_lshl_b32 s54, s54, 14
    s_add_u32 s53, s53, s54
    s_add_u32 s53, s53, 61440
    v_add_u32 v8, s53, v23
    v_add_u32 v9, 32768, v8
    s_mov_b32 s57, 32768
    s_waitcnt vmcnt(0)
    s_mov_b64 exec, 1
    s_cbranch_vccz L_slow52
    buffer_store_dword v59, v58, s[24:27], s55 offen offset:128
L_join53:
    s_mov_b64 exec, -1
    s_setprio 0
L_at_flagD_54:
    v_add_u32 v22, 160384, v22
    ds_read_b128 v[24:27], v22
    ds_read2_b64 v[72:75], v8 offset0:0 offset1:32
    ds_read2_b64 v[88:91], v9 offset0:0 offset1:32
    s_waitcnt lgkmcnt(0)
    v_lshlrev_b32 v12, 16, v24
    v_and_b32 v13, 0xffff0000, v24
    v_lshlrev_b32 v14, 16, v25
    v_and_b32 v15, 0xffff0000, v25
    v_lshlrev_b32 v16, 16, v26
    v_and_b32 v17, 0xffff0000, v26
    v_lshlrev_b32 v18, 16, v27
    v_and_b32 v19, 0xffff0000, v27
    v_lshlrev_b32 v64, 16, v72
    v_and_b32 v65, 0xffff0000, v72
    v_lshlrev_b32 v66, 16, v73
    v_and_b32 v67, 0xffff0000, v73
    v_lshlrev_b32 v68, 16, v74
    v_and_b32 v69, 0xffff0000, v74
    v_lshlrev_b32 v70, 16, v75
    v_and_b32 v71, 0xffff0000, v75
    v_add_f32 v64, v64, v12
    v_add_f32 v65, v65, v13
    v_add_f32 v66, v66, v14
    v_add_f32 v67, v67, v15
    v_add_f32 v68, v68, v16
    v_add_f32 v69, v69, v17
    v_add_f32 v70, v70, v18
    v_add_f32 v71, v71, v19
    v_lshlrev_b32 v80, 16, v88
    v_and_b32 v81, 0xffff0000, v88
    v_lshlrev_b32 v82, 16, v89
    v_and_b32 v83, 0xffff0000, v89
    v_lshlrev_b32 v84, 16, v90
    v_and_b32 v85, 0xffff0000, v90
    v_lshlrev_b32 v86, 16, v91
    v_and_b32 v87, 0xffff0000, v91
    v_add_f32 v80, v80, v12
    v_add_f32 v81, v81, v13
    v_add_f32 v82, v82, v14
    v_add_f32 v83, v83, v15
    v_add_f32 v84, v84, v16
    v_add_f32 v85, v85, v17
    v_add_f32 v86, v86, v18
    v_add_f32 v87, v87, v19
    s_barrier
L_at_R0_55:
    ds_read_b128 v[96:99], v2 offset:0
    ds_read_b128 v[100:103], v3 offset:0
    ds_read_b128 v[104:107], v2 offset:15360
    ds_read_b128 v[108:111], v3 offset:15360
    ds_read_b128 v[112:115], v2 offset:30720
    ds_read_b128 v[116:119], v3 offset:30720
    ds_read_b128 v[120:123], v2 offset:46080
    ds_read_b128 v[124:127], v3 offset:46080
    s_waitcnt lgkmcnt(6)
    v_add_f32 v64, v64, v96
    v_add_f32 v65, v65, v97
    v_add_f32 v66, v66, v98
    v_add_f32 v67, v67, v99
    v_add_f32 v68, v68, v100
    v_add_f32 v69, v69, v101
    v_add_f32 v70, v70, v102
    v_add_f32 v71, v71, v103
    s_waitcnt lgkmcnt(4)
    v_add_f32 v64, v64, v104
    v_add_f32 v65, v65, v105
    v_add_f32 v66, v66, v106
    v_add_f32 v67, v67, v107
    v_add_f32 v68, v68, v108
    v_add_f32 v69, v69, v109
    v_add_f32 v70, v70, v110
    v_add_f32 v71, v71, v111
    s_waitcnt lgkmcnt(2)
    v_add_f32 v64, v64, v112
    v_add_f32 v65, v65, v113
    v_add_f32 v66, v66, v114
    v_add_f32 v67, v67, v115
    v_add_f32 v68, v68, v116
    v_add_f32 v69, v69, v117
    v_add_f32 v70, v70, v118
    v_add_f32 v71, v71, v119
    s_waitcnt lgkmcnt(0)
    v_add_f32 v64, v64, v120
    v_add_f32 v65, v65, v121
    v_add_f32 v66, v66, v122
    v_add_f32 v67, v67, v123
    v_add_f32 v68, v68, v124
    v_add_f32 v69, v69, v125
    v_add_f32 v70, v70, v126
    v_add_f32 v71, v71, v127
    v_cvt_pk_bf16_f32 v76, v64, v65
    v_cvt_pk_bf16_f32 v77, v66, v67
    v_cvt_pk_bf16_f32 v78, v68, v69
    v_cvt_pk_bf16_f32 v79, v70, v71
    buffer_store_dwordx4 v[76:79], v1, s[28:31], s57 offen
    s_barrier
L_at_R1_56:
    ds_read_b128 v[96:99], v4 offset:0
    ds_read_b128 v[100:103], v5 offset:0
    ds_read_b128 v[104:107], v4 offset:8192
    ds_read_b128 v[108:111], v5 offset:8192
    ds_read_b128 v[112:115], v4 offset:16384
    ds_read_b128 v[116:119], v5 offset:16384
    ds_read_b128 v[120:123], v4 offset:24576
    ds_read_b128 v[124:127], v5 offset:24576
    s_waitcnt lgkmcnt(6)
    v_pk_add_f32 v[80:81], v[80:81], v[96:97]
    v_pk_add_f32 v[82:83], v[82:83], v[98:99]
    v_pk_add_f32 v[84:85], v[84:85], v[100:101]
    v_pk_add_f32 v[86:87], v[86:87], v[102:103]
    s_waitcnt lgkmcnt(4)
    v_pk_add_f32 v[80:81], v[80:81], v[104:105]
    v_pk_add_f32 v[82:83], v[82:83], v[106:107]
    v_pk_add_f32 v[84:85], v[84:85], v[108:109]
    v_pk_add_f32 v[86:87], v[86:87], v[110:111]
    s_waitcnt lgkmcnt(2)
    v_pk_add_f32 v[80:81], v[80:81], v[112:113]
    v_pk_add_f32 v[82:83], v[82:83], v[114:115]
    v_pk_add_f32 v[84:85], v[84:85], v[116:117]
    v_pk_add_f32 v[86:87], v[86:87], v[118:119]
    s_waitcnt lgkmcnt(0)
    v_pk_add_f32 v[80:81], v[80:81], v[120:121]
    v_pk_add_f32 v[82:83], v[82:83], v[122:123]
    v_pk_add_f32 v[84:85], v[84:85], v[124:125]
    v_pk_add_f32 v[86:87], v[86:87], v[126:127]
    v_cvt_pk_bf16_f32 v92, v80, v81
    v_cvt_pk_bf16_f32 v93, v82, v83
    v_cvt_pk_bf16_f32 v94, v84, v85
    v_cvt_pk_bf16_f32 v95, v86, v87
    buffer_store_dwordx4 v[92:95], v1, s[28:31], 0 offen
L_at_end_57:
    s_endpgm
L_teamA:
    s_setprio 1
    s_waitcnt lgkmcnt(0)
    s_load_dwordx2 s[24:25], s[0:1], 80
    s_load_dwordx2 s[40:41], s[0:1], 72
    s_load_dwordx2 s[20:21], s[0:1], 48
    s_mov_b32 s26, 16777216
    s_mov_b32 s27, 0x20000
    s_mov_b32 s42, 256
    s_mov_b32 s43, 0x20000
    s_mov_b32 s22, 1409024
    s_mov_b32 s23, 0x20000
    s_mov_b32 s10, 1572864
    s_mov_b32 s11, 0x20000
    s_lshl_b32 s48, s44, 19
    s_lshl2_add_u32 s67, s45, s46
    s_lshl_b32 s51, s2, 2
    s_and_b32 s51, s51, 12
    s_lshr_b32 s52, s2, 3
    s_lshl2_add_u32 s52, s52, s46
    s_mul_i32 s52, s52, 12288
    v_lshlrev_b32 v19, 10, v0
    s_mov_b64 exec, 0xfff
    buffer_load_dword v253, v19, s[8:11], s52 offen offset:384
    s_mov_b64 exec, -1
    v_lshlrev_b32 v1, 4, v0
    v_mov_b32 v2, 0
    v_lshlrev_b32 v3, 2, v0
    s_lshl_b32 s4, s67, 12
    s_add_u32 s4, s4, s48
    s_lshl_b32 s5, s67, 7
    s_add_u32 s5, s5, s48
    s_add_u32 s5, s5, 475136
    v_lshlrev_b32 v19, 21, v0
    v_sub_u32 v19, s5, v19
    v_lshl_add_u32 v19, v0, 13, v19
    s_lshl_b32 s52, s46, 8
    s_add_u32 s52, s52, s48
    s_add_u32 s52, s52, 479232
    v_writelane_b32 v19, s52, 2
    s_add_u32 s52, s52, 128
    v_writelane_b32 v19, s52, 3
    s_waitcnt lgkmcnt(0)
    s_mov_b64 exec, 15
    buffer_load_dword v254, v19, s[24:27], 0 offen sc1
    s_mov_b64 exec, -1
    s_or_b32 s52, s2, s46
    s_cbranch_scc0 L_nolead58x
L_nolead58:
    v_and_b32 v19, 15, v0
    v_lshrrev_b32 v20, 4, v0
    v_lshrrev_b32 v21, 5, v0
    v_lshrrev_b32 v22, 1, v19
    v_xor_b32 v23, v22, v20
    v_lshlrev_b32 v23, 4, v23
    v_lshl_add_u32 v4, v19, 7, v23
    v_xor_b32 v5, 64, v4
    v_xor_b32 v22, v22, v21
    v_lshlrev_b32 v22, 4, v22
    v_lshl_add_u32 v22, v19, 7, v22
    v_and_b32 v23, 1, v20
    v_lshl_add_u32 v22, v23, 3, v22
    s_sub_u32 s7, 0, s47
    s_and_b32 s7, s7, 7
    s_lshl2_add_u32 s52, s7, s46
    s_lshl_b32 s52, s52, 11
    v_add_u32 v176, s52, v22
    v_xor_b32 v178, 32, v176
    v_xor_b32 v180, 64, v176
    v_xor_b32 v182, 96, v176
    v_lshlrev_b32 v22, 4, v19
    v_lshl_add_u32 v22, v23, 14, v22
    v_lshl_add_u32 v18, v21, 8, v22
    s_lshl_b32 s28, s67, 9
    s_add_u32 s28, s28, s48
    s_add_u32 s28, s28, 221184
    s_add_u32 s29, s28, 32768
    s_lshl2_add_u32 s30, s67, s48
    s_add_u32 s30, s30, 479360
    s_lshl_b32 s31, s46, 14
    s_add_u32 s31, s31, s48
    s_add_u32 s31, s31, 221184
    s_lshl_b32 s34, s45, 11
    s_add_u32 s34, s34, s31
    s_add_u32 s34, s34, 90112
    s_lshl_b32 s35, s46, 10
    s_add_u32 s35, s35, s48
    s_add_u32 s35, s35, 466944
    s_lshl_b32 s36, s45, 7
    s_add_u32 s36, s36, s35
    s_add_u32 s37, s31, 90112
    s_cmp_lt_u32 s46, 2
    s_cselect_b32 s52, 12, 8
    s_bfm_b64 s[38:39], s52, 0
    s_mul_i32 s69, s46, 4160
    v_add_u32 v13, s69, v1
    v_lshl_add_u32 v22, v21, 4, v19
    v_lshlrev_b32 v22, 4, v22
    v_add_u32 v23, 512, v22
    s_mov_b32 s60, 0xffff
    s_mov_b32 s61, 0xffff
    v_mov_b32 v14, 1040
    s_mov_b32 exec_lo, 0x00110000
    s_mov_b32 exec_hi, 0x00110000
    v_mov_b32 v14, 1024
    s_mov_b64 exec, -1
    v_cndmask_b32 v22, v14, v22, s[60:61]
    v_cndmask_b32 v23, v14, v23, s[60:61]
    s_add_u32 s53, s69, 1024
    v_add_u32 v14, s53, v22
    v_add_u32 v15, s53, v23
    v_bfe_u32 v22, v0, 3, 2
    v_xor_b32 v22, s46, v22
    v_lshlrev_b32 v22, 5, v22
    v_and_b32 v23, 3, v0
    v_lshl_add_u32 v22, v23, 3, v22
    v_bfe_u32 v23, v0, 2, 2
    v_lshl_add_u32 v22, v23, 7, v22
    v_mul_u32_u24 v23, 3072, v20
    v_add_u32 v8, v22, v23
    v_add_u32 v8, 65536, v8
    v_add_u32 v9, 49152, v8
    v_lshlrev_b32 v10, 2, v19
    v_add_u32 v10, 159744, v10
    v_and_b32 v11, 48, v0
    v_add_u32 v11, 159744, v11
    v_mov_b32 v84, 0
    v_mov_b32 v85, 0
    v_mov_b32 v86, 0
    v_mov_b32 v87, 0
    s_mov_b32 exec_lo, 0x11111111
    s_mov_b32 exec_hi, 0x11111111
    v_mov_b32 v84, 0x3f803f80
    v_mov_b32 v85, 0x3f803f80
    v_mov_b32 v86, 0x3f803f80
    v_mov_b32 v87, 0x3f803f80
    s_mov_b64 exec, -1
    v_mov_b32 v208, 0
    v_mov_b32 v209, 0
    v_mov_b32 v210, 0
    v_mov_b32 v211, 0
    s_mov_b32 exec_lo, 0x10001
    s_mov_b32 exec_hi, 0x10001
    v_mov_b32 v208, 0x3f803f80
    v_mov_b32 v209, 0x3f803f80
    v_mov_b32 v210, 0x3f803f80
    v_mov_b32 v211, 0x3f803f80
    s_mov_b64 exec, -1
    v_add_u32 v22, 1, v0
    v_lshlrev_b32 v22, 19, v22
    v_sub_u32 v22, s5, v22
    s_min_u32 s54, s44, 4
    s_bfm_b64 s[32:33], s54, 0
    v_mov_b32 v23, 0x4000000
    v_cndmask_b32 v16, v23, v22, s[32:33]
    v_and_b32 v22, 7, v0
    s_add_u32 s53, s48, 479232
    v_lshl_add_u32 v17, v22, 2, s53
    v_lshrrev_b32 v22, 3, v0
    v_min_u32 v22, 5, v22
    v_lshl_add_u32 v17, v22, 7, v17
    s_lshl2_add_u32 s6, s45, s53
    s_cmp_eq_u32 s46, 0
    s_cselect_b32 s6, s6, 0x4000000
    v_lshrrev_b32 v22, 1, v0
    v_cmp_gt_u32 s[60:61], s54, v22
    v_and_b32 v22, 3, v22
    v_mul_u32_u24 v22, 12480, v22
    v_and_b32 v23, 7, v0
    v_mul_u32_u24 v23, 2080, v23
    v_add3_u32 v248, v22, v23, s69
    v_and_b32 v23, 8, v0
    v_lshl_add_u32 v248, v23, 1, v248
    v_mov_b32 v23, 0x3f803f80
    v_cndmask_b32 v244, 0, v23, s[60:61]
    v_cndmask_b32 v245, 0, v23, s[60:61]
    v_cndmask_b32 v246, 0, v23, s[60:61]
    v_cndmask_b32 v247, 0, v23, s[60:61]
    v_lshlrev_b32 v22, 2, v21
    v_and_b32 v23, 31, v0
    v_sub_u32 v22, v23, v22
    v_mov_b32 v23, 0xf149f2ca
    v_cmp_le_i32 s[60:61], 0, v22
    v_cmp_le_i32 s[62:63], 1, v22
    v_cmp_le_i32 s[64:65], 2, v22
    v_cndmask_b32 v144, v23, 0, s[60:61]
    v_cndmask_b32 v160, 0, v23, s[60:61]
    v_cmp_le_i32 s[60:61], 3, v22
    v_cndmask_b32 v145, v23, 0, s[62:63]
    v_cndmask_b32 v161, 0, v23, s[62:63]
    v_cmp_le_i32 s[62:63], 8, v22
    v_cndmask_b32 v146, v23, 0, s[64:65]
    v_cndmask_b32 v162, 0, v23, s[64:65]
    v_cmp_le_i32 s[64:65], 9, v22
    v_cndmask_b32 v147, v23, 0, s[60:61]
    v_cndmask_b32 v163, 0, v23, s[60:61]
    v_cmp_le_i32 s[60:61], 10, v22
    v_cndmask_b32 v148, v23, 0, s[62:63]
    v_cndmask_b32 v164, 0, v23, s[62:63]
    v_cmp_le_i32 s[62:63], 11, v22
    v_cndmask_b32 v149, v23, 0, s[64:65]
    v_cndmask_b32 v165, 0, v23, s[64:65]
    v_cmp_le_i32 s[64:65], 16, v22
    v_cndmask_b32 v150, v23, 0, s[60:61]
    v_cndmask_b32 v166, 0, v23, s[60:61]
    v_cmp_le_i32 s[60:61], 17, v22
    v_cndmask_b32 v151, v23, 0, s[62:63]
    v_cndmask_b32 v167, 0, v23, s[62:63]
    v_cmp_le_i32 s[62:63], 18, v22
    v_cndmask_b32 v152, v23, 0, s[64:65]
    v_cndmask_b32 v168, 0, v23, s[64:65]
    v_cmp_le_i32 s[64:65], 19, v22
    v_cndmask_b32 v153, v23, 0, s[60:61]
    v_cndmask_b32 v169, 0, v23, s[60:61]
    v_cmp_le_i32 s[60:61], 24, v22
    v_cndmask_b32 v154, v23, 0, s[62:63]
    v_cndmask_b32 v170, 0, v23, s[62:63]
    v_cmp_le_i32 s[62:63], 25, v22
    v_cndmask_b32 v155, v23, 0, s[64:65]
    v_cndmask_b32 v171, 0, v23, s[64:65]
    v_cmp_le_i32 s[64:65], 26, v22
    v_cndmask_b32 v156, v23, 0, s[60:61]
    v_cndmask_b32 v172, 0, v23, s[60:61]
    v_cmp_le_i32 s[60:61], 27, v22
    v_cndmask_b32 v157, v23, 0, s[62:63]
    v_cndmask_b32 v173, 0, v23, s[62:63]
    v_cndmask_b32 v158, v23, 0, s[64:65]
    v_cndmask_b32 v174, 0, v23, s[64:65]
    v_cndmask_b32 v159, v23, 0, s[60:61]
    v_cndmask_b32 v175, 0, v23, s[60:61]
L_at_pro_59:
    s_barrier
L_at_bar0_60:
    ds_read_b64_tr_b16 v[108:109], v8 offset:1024
    ds_read_b64_tr_b16 v[110:111], v8 offset:1536
    ds_read_b128 v[88:91], v4 offset:0
    ds_read_b64_tr_b16 v[112:113], v8 offset:2048
    ds_read_b64_tr_b16 v[114:115], v8 offset:2560
    ds_read_b128 v[92:95], v4 offset:2048
    ds_read_b64_tr_b16 v[104:105], v8 offset:0
    ds_read_b64_tr_b16 v[106:107], v8 offset:512
    ds_read_b128 v[96:99], v4 offset:4096
    ds_read_b128 v[100:103], v4 offset:6144
    s_waitcnt lgkmcnt(8)
    v_mfma_f32_16x16x32_bf16 v[76:79], v[108:111], v[208:211], 0
    s_waitcnt lgkmcnt(7)
    v_mfma_f32_16x16x32_bf16 v[40:43], v[108:111], v[88:91], 0
    s_waitcnt lgkmcnt(5)
    v_mfma_f32_16x16x32_bf16 v[80:83], v[84:87], v[112:115], 0
    v_mfma_f32_16x16x32_bf16 v[56:59], v[88:91], v[112:115], 0
    s_waitcnt lgkmcnt(4)
    v_mfma_f32_16x16x32_bf16 v[44:47], v[108:111], v[92:95], 0
    v_mfma_f32_16x16x32_bf16 v[60:63], v[92:95], v[112:115], 0
    s_waitcnt lgkmcnt(0)
    s_barrier
    v_mfma_f32_16x16x32_bf16 v[72:75], v[104:107], v[208:211], 0
    ds_read_b64_tr_b16 v[136:137], v8 offset:13312
    ds_read_b64_tr_b16 v[138:139], v8 offset:13824
    v_mfma_f32_16x16x32_bf16 v[24:27], v[104:107], v[88:91], 0
    ds_read_b128 v[116:119], v5 offset:0
    v_mfma_f32_16x16x32_bf16 v[28:31], v[104:107], v[92:95], 0
    ds_read_b64_tr_b16 v[140:141], v8 offset:14336
    v_mfma_f32_16x16x32_bf16 v[48:51], v[108:111], v[96:99], 0
    ds_read_b64_tr_b16 v[142:143], v8 offset:14848
    v_mfma_f32_16x16x32_bf16 v[64:67], v[96:99], v[112:115], 0
    ds_read_b128 v[120:123], v5 offset:2048
    v_mfma_f32_16x16x32_bf16 v[32:35], v[104:107], v[96:99], 0
    ds_read_b64_tr_b16 v[132:133], v8 offset:12288
    v_mfma_f32_16x16x32_bf16 v[52:55], v[108:111], v[100:103], 0
    ds_read_b64_tr_b16 v[134:135], v8 offset:12800
    v_mfma_f32_16x16x32_bf16 v[68:71], v[100:103], v[112:115], 0
    ds_read_b128 v[124:127], v5 offset:4096
    v_mfma_f32_16x16x32_bf16 v[36:39], v[104:107], v[100:103], 0
    ds_read_b128 v[128:131], v5 offset:6144
    s_waitcnt lgkmcnt(8)
    v_mfma_f32_16x16x32_bf16 v[76:79], v[136:139], v[208:211], v[76:79]
    s_waitcnt lgkmcnt(7)
    v_mfma_f32_16x16x32_bf16 v[40:43], v[136:139], v[116:119], v[40:43]
    s_waitcnt lgkmcnt(5)
    v_mfma_f32_16x16x32_bf16 v[80:83], v[84:87], v[140:143], v[80:83]
    v_mfma_f32_16x16x32_bf16 v[56:59], v[116:119], v[140:143], v[56:59]
    s_waitcnt lgkmcnt(4)
    v_mfma_f32_16x16x32_bf16 v[44:47], v[136:139], v[120:123], v[44:47]
    v_mfma_f32_16x16x32_bf16 v[60:63], v[120:123], v[140:143], v[60:63]
    s_branch L_pg61
.p2align 12
L_pg61:
    s_waitcnt lgkmcnt(0)
    s_barrier
    v_mfma_f32_16x16x32_bf16 v[72:75], v[132:135], v[208:211], v[72:75]
    ds_read_b64_tr_b16 v[108:109], v8 offset:25600
    ds_read_b64_tr_b16 v[110:111], v8 offset:26112
    v_mfma_f32_16x16x32_bf16 v[24:27], v[132:135], v[116:119], v[24:27]
    ds_read_b128 v[88:91], v4 offset:8192
    v_mfma_f32_16x16x32_bf16 v[28:31], v[132:135], v[120:123], v[28:31]
    ds_read_b64_tr_b16 v[112:113], v8 offset:26624
    v_mfma_f32_16x16x32_bf16 v[48:51], v[136:139], v[124:127], v[48:51]
    ds_read_b64_tr_b16 v[114:115], v8 offset:27136
    v_mfma_f32_16x16x32_bf16 v[64:67], v[124:127], v[140:143], v[64:67]
    ds_read_b128 v[92:95], v4 offset:10240
    v_mfma_f32_16x16x32_bf16 v[32:35], v[132:135], v[124:127], v[32:35]
    ds_read_b64_tr_b16 v[104:105], v8 offset:24576
    v_mfma_f32_16x16x32_bf16 v[52:55], v[136:139], v[128:131], v[52:55]
    ds_read_b64_tr_b16 v[106:107], v8 offset:25088
    v_mfma_f32_16x16x32_bf16 v[68:71], v[128:131], v[140:143], v[68:71]
    ds_read_b128 v[96:99], v4 offset:12288
    v_mfma_f32_16x16x32_bf16 v[36:39], v[132:135], v[128:131], v[36:39]
    ds_read_b128 v[100:103], v4 offset:14336
    s_waitcnt lgkmcnt(8)
    v_mfma_f32_16x16x32_bf16 v[76:79], v[108:111], v[208:211], v[76:79]
    s_waitcnt lgkmcnt(7)
    v_mfma_f32_16x16x32_bf16 v[40:43], v[108:111], v[88:91], v[40:43]
    s_waitcnt lgkmcnt(5)
    v_mfma_f32_16x16x32_bf16 v[80:83], v[84:87], v[112:115], v[80:83]
    v_mfma_f32_16x16x32_bf16 v[56:59], v[88:91], v[112:115], v[56:59]
    s_waitcnt lgkmcnt(4)
    v_mfma_f32_16x16x32_bf16 v[44:47], v[108:111], v[92:95], v[44:47]
    v_mfma_f32_16x16x32_bf16 v[60:63], v[92:95], v[112:115], v[60:63]
    s_waitcnt lgkmcnt(0)
    s_barrier
    v_mfma_f32_16x16x32_bf16 v[72:75], v[104:107], v[208:211], v[72:75]
    ds_read_b64_tr_b16 v[136:137], v8 offset:37888
    ds_read_b64_tr_b16 v[138:139], v8 offset:38400
    v_mfma_f32_16x16x32_bf16 v[24:27], v[104:107], v[88:91], v[24:27]
    ds_read_b128 v[116:119], v5 offset:8192
    v_mfma_f32_16x16x32_bf16 v[28:31], v[104:107], v[92:95], v[28:31]
    ds_read_b64_tr_b16 v[140:141], v8 offset:38912
    v_mfma_f32_16x16x32_bf16 v[48:51], v[108:111], v[96:99], v[48:51]
    ds_read_b64_tr_b16 v[142:143], v8 offset:39424
    v_mfma_f32_16x16x32_bf16 v[64:67], v[96:99], v[112:115], v[64:67]
    ds_read_b128 v[120:123], v5 offset:10240
    v_mfma_f32_16x16x32_bf16 v[32:35], v[104:107], v[96:99], v[32:35]
    ds_read_b64_tr_b16 v[132:133], v8 offset:36864
    v_mfma_f32_16x16x32_bf16 v[52:55], v[108:111], v[100:103], v[52:55]
    ds_read_b64_tr_b16 v[134:135], v8 offset:37376
    v_mfma_f32_16x16x32_bf16 v[68:71], v[100:103], v[112:115], v[68:71]
    ds_read_b128 v[124:127], v5 offset:12288
    v_mfma_f32_16x16x32_bf16 v[36:39], v[104:107], v[100:103], v[36:39]
    ds_read_b128 v[128:131], v5 offset:14336
    s_waitcnt lgkmcnt(8)
    v_mfma_f32_16x16x32_bf16 v[76:79], v[136:139], v[208:211], v[76:79]
    s_waitcnt lgkmcnt(7)
    v_mfma_f32_16x16x32_bf16 v[40:43], v[136:139], v[116:119], v[40:43]
    s_waitcnt lgkmcnt(5)
    v_mfma_f32_16x16x32_bf16 v[80:83], v[84:87], v[140:143], v[80:83]
    v_mfma_f32_16x16x32_bf16 v[56:59], v[116:119], v[140:143], v[56:59]
    s_waitcnt lgkmcnt(4)
    v_mfma_f32_16x16x32_bf16 v[44:47], v[136:139], v[120:123], v[44:47]
    v_mfma_f32_16x16x32_bf16 v[60:63], v[120:123], v[140:143], v[60:63]
    s_waitcnt lgkmcnt(0)
    s_barrier
    v_mfma_f32_16x16x32_bf16 v[72:75], v[132:135], v[208:211], v[72:75]
    ds_read_b64_tr_b16 v[108:109], v9 offset:1024
    ds_read_b64_tr_b16 v[110:111], v9 offset:1536
    v_mfma_f32_16x16x32_bf16 v[24:27], v[132:135], v[116:119], v[24:27]
    ds_read_b128 v[88:91], v4 offset:16384
    v_mfma_f32_16x16x32_bf16 v[28:31], v[132:135], v[120:123], v[28:31]
    ds_read_b64_tr_b16 v[112:113], v9 offset:2048
    v_mfma_f32_16x16x32_bf16 v[48:51], v[136:139], v[124:127], v[48:51]
    ds_read_b64_tr_b16 v[114:115], v9 offset:2560
    v_mfma_f32_16x16x32_bf16 v[64:67], v[124:127], v[140:143], v[64:67]
    ds_read_b128 v[92:95], v4 offset:18432
    v_mfma_f32_16x16x32_bf16 v[32:35], v[132:135], v[124:127], v[32:35]
    ds_read_b64_tr_b16 v[104:105], v9 offset:0
    v_mfma_f32_16x16x32_bf16 v[52:55], v[136:139], v[128:131], v[52:55]
    ds_read_b64_tr_b16 v[106:107], v9 offset:512
    v_mfma_f32_16x16x32_bf16 v[68:71], v[128:131], v[140:143], v[68:71]
    ds_read_b128 v[96:99], v4 offset:20480
    v_mfma_f32_16x16x32_bf16 v[36:39], v[132:135], v[128:131], v[36:39]
    ds_read_b128 v[100:103], v4 offset:22528
    s_waitcnt lgkmcnt(8)
    v_mfma_f32_16x16x32_bf16 v[76:79], v[108:111], v[208:211], v[76:79]
    s_waitcnt lgkmcnt(7)
    v_mfma_f32_16x16x32_bf16 v[40:43], v[108:111], v[88:91], v[40:43]
    s_waitcnt lgkmcnt(5)
    v_mfma_f32_16x16x32_bf16 v[80:83], v[84:87], v[112:115], v[80:83]
    v_mfma_f32_16x16x32_bf16 v[56:59], v[88:91], v[112:115], v[56:59]
    s_waitcnt lgkmcnt(4)
    v_mfma_f32_16x16x32_bf16 v[44:47], v[108:111], v[92:95], v[44:47]
    v_mfma_f32_16x16x32_bf16 v[60:63], v[92:95], v[112:115], v[60:63]
    s_waitcnt lgkmcnt(0)
    s_barrier
    v_mfma_f32_16x16x32_bf16 v[72:75], v[104:107], v[208:211], v[72:75]
    ds_read_b64_tr_b16 v[136:137], v9 offset:13312
    ds_read_b64_tr_b16 v[138:139], v9 offset:13824
    v_mfma_f32_16x16x32_bf16 v[24:27], v[104:107], v[88:91], v[24:27]
    ds_read_b128 v[116:119], v5 offset:16384
    v_mfma_f32_16x16x32_bf16 v[28:31], v[104:107], v[92:95], v[28:31]
    ds_read_b64_tr_b16 v[140:141], v9 offset:14336
    v_mfma_f32_16x16x32_bf16 v[48:51], v[108:111], v[96:99], v[48:51]
    ds_read_b64_tr_b16 v[142:143], v9 offset:14848
    v_mfma_f32_16x16x32_bf16 v[64:67], v[96:99], v[112:115], v[64:67]
    ds_read_b128 v[120:123], v5 offset:18432
    v_mfma_f32_16x16x32_bf16 v[32:35], v[104:107], v[96:99], v[32:35]
    ds_read_b64_tr_b16 v[132:133], v9 offset:12288
    v_mfma_f32_16x16x32_bf16 v[52:55], v[108:111], v[100:103], v[52:55]
    ds_read_b64_tr_b16 v[134:135], v9 offset:12800
    v_mfma_f32_16x16x32_bf16 v[68:71], v[100:103], v[112:115], v[68:71]
    ds_read_b128 v[124:127], v5 offset:20480
    v_mfma_f32_16x16x32_bf16 v[36:39], v[104:107], v[100:103], v[36:39]
    ds_read_b128 v[128:131], v5 offset:22528
    s_waitcnt lgkmcnt(8)
    v_mfma_f32_16x16x32_bf16 v[76:79], v[136:139], v[208:211], v[76:79]
    s_waitcnt lgkmcnt(7)
    v_mfma_f32_16x16x32_bf16 v[40:43], v[136:139], v[116:119], v[40:43]
    s_waitcnt lgkmcnt(5)
    v_mfma_f32_16x16x32_bf16 v[80:83], v[84:87], v[140:143], v[80:83]
    v_mfma_f32_16x16x32_bf16 v[56:59], v[116:119], v[140:143], v[56:59]
    s_waitcnt lgkmcnt(4)
    v_mfma_f32_16x16x32_bf16 v[44:47], v[136:139], v[120:123], v[44:47]
    v_mfma_f32_16x16x32_bf16 v[60:63], v[120:123], v[140:143], v[60:63]
    s_waitcnt lgkmcnt(0)
    s_barrier
    v_mfma_f32_16x16x32_bf16 v[72:75], v[132:135], v[208:211], v[72:75]
    ds_read_b64_tr_b16 v[108:109], v8 offset:1024
    ds_read_b64_tr_b16 v[110:111], v8 offset:1536
    v_mfma_f32_16x16x32_bf16 v[24:27], v[132:135], v[116:119], v[24:27]
    ds_read_b128 v[88:91], v4 offset:24576
    v_mfma_f32_16x16x32_bf16 v[28:31], v[132:135], v[120:123], v[28:31]
    ds_read_b64_tr_b16 v[112:113], v8 offset:2048
    v_mfma_f32_16x16x32_bf16 v[48:51], v[136:139], v[124:127], v[48:51]
    ds_read_b64_tr_b16 v[114:115], v8 offset:2560
    v_mfma_f32_16x16x32_bf16 v[64:67], v[124:127], v[140:143], v[64:67]
    ds_read_b128 v[92:95], v4 offset:26624
    v_mfma_f32_16x16x32_bf16 v[32:35], v[132:135], v[124:127], v[32:35]
    ds_read_b64_tr_b16 v[104:105], v8 offset:0
    v_mfma_f32_16x16x32_bf16 v[52:55], v[136:139], v[128:131], v[52:55]
    ds_read_b64_tr_b16 v[106:107], v8 offset:512
    v_mfma_f32_16x16x32_bf16 v[68:71], v[128:131], v[140:143], v[68:71]
    ds_read_b128 v[96:99], v4 offset:28672
    v_mfma_f32_16x16x32_bf16 v[36:39], v[132:135], v[128:131], v[36:39]
    ds_read_b128 v[100:103], v4 offset:30720
    s_waitcnt lgkmcnt(8)
    v_mfma_f32_16x16x32_bf16 v[76:79], v[108:111], v[208:211], v[76:79]
    s_waitcnt lgkmcnt(7)
    v_mfma_f32_16x16x32_bf16 v[40:43], v[108:111], v[88:91], v[40:43]
    s_waitcnt lgkmcnt(5)
    v_mfma_f32_16x16x32_bf16 v[80:83], v[84:87], v[112:115], v[80:83]
    v_mfma_f32_16x16x32_bf16 v[56:59], v[88:91], v[112:115], v[56:59]
    s_waitcnt lgkmcnt(4)
    v_mfma_f32_16x16x32_bf16 v[44:47], v[108:111], v[92:95], v[44:47]
    v_mfma_f32_16x16x32_bf16 v[60:63], v[92:95], v[112:115], v[60:63]
    s_waitcnt lgkmcnt(0)
    s_barrier
    v_mfma_f32_16x16x32_bf16 v[72:75], v[104:107], v[208:211], v[72:75]
    ds_read_b64_tr_b16 v[136:137], v8 offset:13312
    ds_read_b64_tr_b16 v[138:139], v8 offset:13824
    v_mfma_f32_16x16x32_bf16 v[24:27], v[104:107], v[88:91], v[24:27]
    ds_read_b128 v[116:119], v5 offset:24576
    v_mfma_f32_16x16x32_bf16 v[28:31], v[104:107], v[92:95], v[28:31]
    ds_read_b64_tr_b16 v[140:141], v8 offset:14336
    v_mfma_f32_16x16x32_bf16 v[48:51], v[108:111], v[96:99], v[48:51]
    ds_read_b64_tr_b16 v[142:143], v8 offset:14848
    v_mfma_f32_16x16x32_bf16 v[64:67], v[96:99], v[112:115], v[64:67]
    ds_read_b128 v[120:123], v5 offset:26624
    v_mfma_f32_16x16x32_bf16 v[32:35], v[104:107], v[96:99], v[32:35]
    ds_read_b64_tr_b16 v[132:133], v8 offset:12288
    v_mfma_f32_16x16x32_bf16 v[52:55], v[108:111], v[100:103], v[52:55]
    ds_read_b64_tr_b16 v[134:135], v8 offset:12800
    v_mfma_f32_16x16x32_bf16 v[68:71], v[100:103], v[112:115], v[68:71]
    ds_read_b128 v[124:127], v5 offset:28672
    v_mfma_f32_16x16x32_bf16 v[36:39], v[104:107], v[100:103], v[36:39]
    ds_read_b128 v[128:131], v5 offset:30720
    s_waitcnt lgkmcnt(8)
    v_mfma_f32_16x16x32_bf16 v[76:79], v[136:139], v[208:211], v[76:79]
    s_waitcnt lgkmcnt(7)
    v_mfma_f32_16x16x32_bf16 v[40:43], v[136:139], v[116:119], v[40:43]
    s_waitcnt lgkmcnt(5)
    v_mfma_f32_16x16x32_bf16 v[80:83], v[84:87], v[140:143], v[80:83]
    v_mfma_f32_16x16x32_bf16 v[56:59], v[116:119], v[140:143], v[56:59]
    s_waitcnt lgkmcnt(4)
    v_mfma_f32_16x16x32_bf16 v[44:47], v[136:139], v[120:123], v[44:47]
    v_mfma_f32_16x16x32_bf16 v[60:63], v[120:123], v[140:143], v[60:63]
    s_waitcnt lgkmcnt(0)
    s_barrier
    v_mfma_f32_16x16x32_bf16 v[72:75], v[132:135], v[208:211], v[72:75]
    ds_read_b64_tr_b16 v[108:109], v8 offset:25600
    ds_read_b64_tr_b16 v[110:111], v8 offset:26112
    v_mfma_f32_16x16x32_bf16 v[24:27], v[132:135], v[116:119], v[24:27]
    ds_read_b128 v[88:91], v4 offset:32768
    v_mfma_f32_16x16x32_bf16 v[28:31], v[132:135], v[120:123], v[28:31]
    ds_read_b64_tr_b16 v[112:113], v8 offset:26624
    v_mfma_f32_16x16x32_bf16 v[48:51], v[136:139], v[124:127], v[48:51]
    ds_read_b64_tr_b16 v[114:115], v8 offset:27136
    v_mfma_f32_16x16x32_bf16 v[64:67], v[124:127], v[140:143], v[64:67]
    ds_read_b128 v[92:95], v4 offset:34816
    v_mfma_f32_16x16x32_bf16 v[32:35], v[132:135], v[124:127], v[32:35]
    ds_read_b64_tr_b16 v[104:105], v8 offset:24576
    v_mfma_f32_16x16x32_bf16 v[52:55], v[136:139], v[128:131], v[52:55]
    ds_read_b64_tr_b16 v[106:107], v8 offset:25088
    v_mfma_f32_16x16x32_bf16 v[68:71], v[128:131], v[140:143], v[68:71]
    ds_read_b128 v[96:99], v4 offset:36864
    v_mfma_f32_16x16x32_bf16 v[36:39], v[132:135], v[128:131], v[36:39]
    ds_read_b128 v[100:103], v4 offset:38912
    s_waitcnt lgkmcnt(8)
    v_mfma_f32_16x16x32_bf16 v[76:79], v[108:111], v[208:211], v[76:79]
    s_waitcnt lgkmcnt(7)
    v_mfma_f32_16x16x32_bf16 v[40:43], v[108:111], v[88:91], v[40:43]
    s_waitcnt lgkmcnt(5)
    v_mfma_f32_16x16x32_bf16 v[80:83], v[84:87], v[112:115], v[80:83]
    v_mfma_f32_16x16x32_bf16 v[56:59], v[88:91], v[112:115], v[56:59]
    s_waitcnt lgkmcnt(4)
    v_mfma_f32_16x16x32_bf16 v[44:47], v[108:111], v[92:95], v[44:47]
    v_mfma_f32_16x16x32_bf16 v[60:63], v[92:95], v[112:115], v[60:63]
    s_waitcnt lgkmcnt(0)
    s_barrier
    v_mfma_f32_16x16x32_bf16 v[72:75], v[104:107], v[208:211], v[72:75]
    ds_read_b64_tr_b16 v[136:137], v8 offset:37888
    ds_read_b64_tr_b16 v[138:139], v8 offset:38400
    v_mfma_f32_16x16x32_bf16 v[24:27], v[104:107], v[88:91], v[24:27]
    ds_read_b128 v[116:119], v5 offset:32768
    v_mfma_f32_16x16x32_bf16 v[28:31], v[104:107], v[92:95], v[28:31]
    ds_read_b64_tr_b16 v[140:141], v8 offset:38912
    v_mfma_f32_16x16x32_bf16 v[48:51], v[108:111], v[96:99], v[48:51]
    ds_read_b64_tr_b16 v[142:143], v8 offset:39424
    v_mfma_f32_16x16x32_bf16 v[64:67], v[96:99], v[112:115], v[64:67]
    ds_read_b128 v[120:123], v5 offset:34816
    v_mfma_f32_16x16x32_bf16 v[32:35], v[104:107], v[96:99], v[32:35]
    ds_read_b64_tr_b16 v[132:133], v8 offset:36864
    v_mfma_f32_16x16x32_bf16 v[52:55], v[108:111], v[100:103], v[52:55]
    ds_read_b64_tr_b16 v[134:135], v8 offset:37376
    v_mfma_f32_16x16x32_bf16 v[68:71], v[100:103], v[112:115], v[68:71]
    ds_read_b128 v[124:127], v5 offset:36864
    v_mfma_f32_16x16x32_bf16 v[36:39], v[104:107], v[100:103], v[36:39]
    ds_read_b128 v[128:131], v5 offset:38912
    s_waitcnt lgkmcnt(8)
    v_mfma_f32_16x16x32_bf16 v[76:79], v[136:139], v[208:211], v[76:79]
    s_waitcnt lgkmcnt(7)
    v_mfma_f32_16x16x32_bf16 v[40:43], v[136:139], v[116:119], v[40:43]
    s_waitcnt lgkmcnt(5)
    v_mfma_f32_16x16x32_bf16 v[80:83], v[84:87], v[140:143], v[80:83]
    v_mfma_f32_16x16x32_bf16 v[56:59], v[116:119], v[140:143], v[56:59]
    s_waitcnt lgkmcnt(4)
    v_mfma_f32_16x16x32_bf16 v[44:47], v[136:139], v[120:123], v[44:47]
    v_mfma_f32_16x16x32_bf16 v[60:63], v[120:123], v[140:143], v[60:63]
    s_waitcnt lgkmcnt(0)
    s_barrier
    v_mfma_f32_16x16x32_bf16 v[72:75], v[132:135], v[208:211], v[72:75]
    ds_read_b64_tr_b16 v[108:109], v9 offset:1024
    ds_read_b64_tr_b16 v[110:111], v9 offset:1536
    v_mfma_f32_16x16x32_bf16 v[24:27], v[132:135], v[116:119], v[24:27]
    ds_read_b128 v[88:91], v4 offset:40960
    v_mfma_f32_16x16x32_bf16 v[28:31], v[132:135], v[120:123], v[28:31]
    ds_read_b64_tr_b16 v[112:113], v9 offset:2048
    v_mfma_f32_16x16x32_bf16 v[48:51], v[136:139], v[124:127], v[48:51]
    ds_read_b64_tr_b16 v[114:115], v9 offset:2560
    v_mfma_f32_16x16x32_bf16 v[64:67], v[124:127], v[140:143], v[64:67]
    ds_read_b128 v[92:95], v4 offset:43008
    v_mfma_f32_16x16x32_bf16 v[32:35], v[132:135], v[124:127], v[32:35]
    ds_read_b64_tr_b16 v[104:105], v9 offset:0
    v_mfma_f32_16x16x32_bf16 v[52:55], v[136:139], v[128:131], v[52:55]
    ds_read_b64_tr_b16 v[106:107], v9 offset:512
    v_mfma_f32_16x16x32_bf16 v[68:71], v[128:131], v[140:143], v[68:71]
    ds_read_b128 v[96:99], v4 offset:45056
    v_mfma_f32_16x16x32_bf16 v[36:39], v[132:135], v[128:131], v[36:39]
    ds_read_b128 v[100:103], v4 offset:47104
    s_waitcnt lgkmcnt(8)
    v_mfma_f32_16x16x32_bf16 v[76:79], v[108:111], v[208:211], v[76:79]
    s_waitcnt lgkmcnt(7)
    v_mfma_f32_16x16x32_bf16 v[40:43], v[108:111], v[88:91], v[40:43]
    s_waitcnt lgkmcnt(5)
    v_mfma_f32_16x16x32_bf16 v[80:83], v[84:87], v[112:115], v[80:83]
    v_mfma_f32_16x16x32_bf16 v[56:59], v[88:91], v[112:115], v[56:59]
    s_waitcnt lgkmcnt(4)
    v_mfma_f32_16x16x32_bf16 v[44:47], v[108:111], v[92:95], v[44:47]
    v_mfma_f32_16x16x32_bf16 v[60:63], v[92:95], v[112:115], v[60:63]
    s_waitcnt lgkmcnt(0)
    s_barrier
    buffer_load_dwordx2 v[20:21], v2, s[40:43], 0 offen sc1
    v_mfma_f32_16x16x32_bf16 v[72:75], v[104:107], v[208:211], v[72:75]
    ds_read_b64_tr_b16 v[136:137], v9 offset:13312
    ds_read_b64_tr_b16 v[138:139], v9 offset:13824
    v_mfma_f32_16x16x32_bf16 v[24:27], v[104:107], v[88:91], v[24:27]
    ds_read_b128 v[116:119], v5 offset:40960
    v_mfma_f32_16x16x32_bf16 v[28:31], v[104:107], v[92:95], v[28:31]
    ds_read_b64_tr_b16 v[140:141], v9 offset:14336
    v_mfma_f32_16x16x32_bf16 v[48:51], v[108:111], v[96:99], v[48:51]
    ds_read_b64_tr_b16 v[142:143], v9 offset:14848
    v_mfma_f32_16x16x32_bf16 v[64:67], v[96:99], v[112:115], v[64:67]
    ds_read_b128 v[120:123], v5 offset:43008
    v_mfma_f32_16x16x32_bf16 v[32:35], v[104:107], v[96:99], v[32:35]
    ds_read_b64_tr_b16 v[132:133], v9 offset:12288
    v_mfma_f32_16x16x32_bf16 v[52:55], v[108:111], v[100:103], v[52:55]
    ds_read_b64_tr_b16 v[134:135], v9 offset:12800
    v_mfma_f32_16x16x32_bf16 v[68:71], v[100:103], v[112:115], v[68:71]
    ds_read_b128 v[124:127], v5 offset:45056
    v_mfma_f32_16x16x32_bf16 v[36:39], v[104:107], v[100:103], v[36:39]
    ds_read_b128 v[128:131], v5 offset:47104
    s_waitcnt lgkmcnt(8)
    v_mfma_f32_16x16x32_bf16 v[76:79], v[136:139], v[208:211], v[76:79]
    s_waitcnt lgkmcnt(7)
    v_mfma_f32_16x16x32_bf16 v[40:43], v[136:139], v[116:119], v[40:43]
    s_waitcnt lgkmcnt(5)
    v_mfma_f32_16x16x32_bf16 v[80:83], v[84:87], v[140:143], v[80:83]
    v_mfma_f32_16x16x32_bf16 v[56:59], v[116:119], v[140:143], v[56:59]
    s_waitcnt lgkmcnt(4)
    v_mfma_f32_16x16x32_bf16 v[44:47], v[136:139], v[120:123], v[44:47]
    v_mfma_f32_16x16x32_bf16 v[60:63], v[120:123], v[140:143], v[60:63]
    s_waitcnt lgkmcnt(0)
    s_barrier
    v_mfma_f32_16x16x32_bf16 v[72:75], v[132:135], v[208:211], v[72:75]
    ds_read_b64_tr_b16 v[108:109], v8 offset:1024
    ds_read_b64_tr_b16 v[110:111], v8 offset:1536
    v_mfma_f32_16x16x32_bf16 v[24:27], v[132:135], v[116:119], v[24:27]
    ds_read_b128 v[88:91], v4 offset:49152
    v_mfma_f32_16x16x32_bf16 v[28:31], v[132:135], v[120:123], v[28:31]
    ds_read_b64_tr_b16 v[112:113], v8 offset:2048
    v_mfma_f32_16x16x32_bf16 v[48:51], v[136:139], v[124:127], v[48:51]
    ds_read_b64_tr_b16 v[114:115], v8 offset:2560
    v_mfma_f32_16x16x32_bf16 v[64:67], v[124:127], v[140:143], v[64:67]
    ds_read_b128 v[92:95], v4 offset:51200
    v_mfma_f32_16x16x32_bf16 v[32:35], v[132:135], v[124:127], v[32:35]
    ds_read_b64_tr_b16 v[104:105], v8 offset:0
    v_mfma_f32_16x16x32_bf16 v[52:55], v[136:139], v[128:131], v[52:55]
    ds_read_b64_tr_b16 v[106:107], v8 offset:512
    v_mfma_f32_16x16x32_bf16 v[68:71], v[128:131], v[140:143], v[68:71]
    ds_read_b128 v[96:99], v4 offset:53248
    v_mfma_f32_16x16x32_bf16 v[36:39], v[132:135], v[128:131], v[36:39]
    ds_read_b128 v[100:103], v4 offset:55296
    s_waitcnt lgkmcnt(8)
    v_mfma_f32_16x16x32_bf16 v[76:79], v[108:111], v[208:211], v[76:79]
    s_waitcnt lgkmcnt(7)
    v_mfma_f32_16x16x32_bf16 v[40:43], v[108:111], v[88:91], v[40:43]
    s_waitcnt lgkmcnt(5)
    v_mfma_f32_16x16x32_bf16 v[80:83], v[84:87], v[112:115], v[80:83]
    v_mfma_f32_16x16x32_bf16 v[56:59], v[88:91], v[112:115], v[56:59]
    s_waitcnt lgkmcnt(4)
    v_mfma_f32_16x16x32_bf16 v[44:47], v[108:111], v[92:95], v[44:47]
    v_mfma_f32_16x16x32_bf16 v[60:63], v[92:95], v[112:115], v[60:63]
    s_waitcnt lgkmcnt(0)
    s_barrier
    v_mfma_f32_16x16x32_bf16 v[72:75], v[104:107], v[208:211], v[72:75]
    ds_read_b64_tr_b16 v[136:137], v8 offset:13312
    ds_read_b64_tr_b16 v[138:139], v8 offset:13824
    v_mfma_f32_16x16x32_bf16 v[24:27], v[104:107], v[88:91], v[24:27]
    ds_read_b128 v[116:119], v5 offset:49152
    v_mfma_f32_16x16x32_bf16 v[28:31], v[104:107], v[92:95], v[28:31]
    ds_read_b64_tr_b16 v[140:141], v8 offset:14336
    v_mfma_f32_16x16x32_bf16 v[48:51], v[108:111], v[96:99], v[48:51]
    ds_read_b64_tr_b16 v[142:143], v8 offset:14848
    v_mfma_f32_16x16x32_bf16 v[64:67], v[96:99], v[112:115], v[64:67]
    ds_read_b128 v[120:123], v5 offset:51200
    v_mfma_f32_16x16x32_bf16 v[32:35], v[104:107], v[96:99], v[32:35]
    ds_read_b64_tr_b16 v[132:133], v8 offset:12288
    v_mfma_f32_16x16x32_bf16 v[52:55], v[108:111], v[100:103], v[52:55]
    ds_read_b64_tr_b16 v[134:135], v8 offset:12800
    v_mfma_f32_16x16x32_bf16 v[68:71], v[100:103], v[112:115], v[68:71]
    ds_read_b128 v[124:127], v5 offset:53248
    v_mfma_f32_16x16x32_bf16 v[36:39], v[104:107], v[100:103], v[36:39]
    ds_read_b128 v[128:131], v5 offset:55296
    s_waitcnt lgkmcnt(8)
    v_mfma_f32_16x16x32_bf16 v[76:79], v[136:139], v[208:211], v[76:79]
    s_waitcnt lgkmcnt(7)
    v_mfma_f32_16x16x32_bf16 v[40:43], v[136:139], v[116:119], v[40:43]
    s_waitcnt lgkmcnt(5)
    v_mfma_f32_16x16x32_bf16 v[80:83], v[84:87], v[140:143], v[80:83]
    v_mfma_f32_16x16x32_bf16 v[56:59], v[116:119], v[140:143], v[56:59]
    s_waitcnt lgkmcnt(4)
    v_mfma_f32_16x16x32_bf16 v[44:47], v[136:139], v[120:123], v[44:47]
    v_mfma_f32_16x16x32_bf16 v[60:63], v[120:123], v[140:143], v[60:63]
    s_waitcnt lgkmcnt(0)
    s_barrier
    v_mfma_f32_16x16x32_bf16 v[72:75], v[132:135], v[208:211], v[72:75]
    ds_read_b64_tr_b16 v[108:109], v8 offset:25600
    ds_read_b64_tr_b16 v[110:111], v8 offset:26112
    v_mfma_f32_16x16x32_bf16 v[24:27], v[132:135], v[116:119], v[24:27]
    ds_read_b128 v[88:91], v4 offset:57344
    v_mfma_f32_16x16x32_bf16 v[28:31], v[132:135], v[120:123], v[28:31]
    ds_read_b64_tr_b16 v[112:113], v8 offset:26624
    v_mfma_f32_16x16x32_bf16 v[48:51], v[136:139], v[124:127], v[48:51]
    ds_read_b64_tr_b16 v[114:115], v8 offset:27136
    v_mfma_f32_16x16x32_bf16 v[64:67], v[124:127], v[140:143], v[64:67]
    ds_read_b128 v[92:95], v4 offset:59392
    v_mfma_f32_16x16x32_bf16 v[32:35], v[132:135], v[124:127], v[32:35]
    ds_read_b64_tr_b16 v[104:105], v8 offset:24576
    v_mfma_f32_16x16x32_bf16 v[52:55], v[136:139], v[128:131], v[52:55]
    ds_read_b64_tr_b16 v[106:107], v8 offset:25088
    v_mfma_f32_16x16x32_bf16 v[68:71], v[128:131], v[140:143], v[68:71]
    ds_read_b128 v[96:99], v4 offset:61440
    v_mfma_f32_16x16x32_bf16 v[36:39], v[132:135], v[128:131], v[36:39]
    ds_read_b128 v[100:103], v4 offset:63488
    s_waitcnt lgkmcnt(8)
    v_mfma_f32_16x16x32_bf16 v[76:79], v[108:111], v[208:211], v[76:79]
    s_waitcnt lgkmcnt(7)
    v_mfma_f32_16x16x32_bf16 v[40:43], v[108:111], v[88:91], v[40:43]
    s_waitcnt lgkmcnt(5)
    v_mfma_f32_16x16x32_bf16 v[80:83], v[84:87], v[112:115], v[80:83]
    v_mfma_f32_16x16x32_bf16 v[56:59], v[88:91], v[112:115], v[56:59]
    s_waitcnt lgkmcnt(4)
    v_mfma_f32_16x16x32_bf16 v[44:47], v[108:111], v[92:95], v[44:47]
    v_mfma_f32_16x16x32_bf16 v[60:63], v[92:95], v[112:115], v[60:63]
    s_waitcnt lgkmcnt(0)
    s_barrier
    v_mfma_f32_16x16x32_bf16 v[72:75], v[104:107], v[208:211], v[72:75]
    ds_read_b64_tr_b16 v[136:137], v8 offset:37888
    ds_read_b64_tr_b16 v[138:139], v8 offset:38400
    v_mfma_f32_16x16x32_bf16 v[24:27], v[104:107], v[88:91], v[24:27]
    ds_read_b128 v[116:119], v5 offset:57344
    v_mfma_f32_16x16x32_bf16 v[28:31], v[104:107], v[92:95], v[28:31]
    ds_read_b64_tr_b16 v[140:141], v8 offset:38912
    v_mfma_f32_16x16x32_bf16 v[48:51], v[108:111], v[96:99], v[48:51]
    ds_read_b64_tr_b16 v[142:143], v8 offset:39424
    v_mfma_f32_16x16x32_bf16 v[64:67], v[96:99], v[112:115], v[64:67]
    ds_read_b128 v[120:123], v5 offset:59392
    v_mfma_f32_16x16x32_bf16 v[32:35], v[104:107], v[96:99], v[32:35]
    ds_read_b64_tr_b16 v[132:133], v8 offset:36864
    v_mfma_f32_16x16x32_bf16 v[52:55], v[108:111], v[100:103], v[52:55]
    ds_read_b64_tr_b16 v[134:135], v8 offset:37376
    v_mfma_f32_16x16x32_bf16 v[68:71], v[100:103], v[112:115], v[68:71]
    ds_read_b128 v[124:127], v5 offset:61440
    v_mfma_f32_16x16x32_bf16 v[36:39], v[104:107], v[100:103], v[36:39]
    ds_read_b128 v[128:131], v5 offset:63488
    s_waitcnt lgkmcnt(8)
    v_mfma_f32_16x16x32_bf16 v[76:79], v[136:139], v[208:211], v[76:79]
    ds_read_b64 v[176:177], v176
    s_waitcnt lgkmcnt(8)
    v_mfma_f32_16x16x32_bf16 v[40:43], v[136:139], v[116:119], v[40:43]
    ds_read_b64 v[178:179], v178
    s_waitcnt lgkmcnt(7)
    v_mfma_f32_16x16x32_bf16 v[80:83], v[84:87], v[140:143], v[80:83]
    ds_read_b64 v[180:181], v180
    v_mfma_f32_16x16x32_bf16 v[56:59], v[116:119], v[140:143], v[56:59]
    ds_read_b64 v[182:183], v182
    s_waitcnt lgkmcnt(8)
    v_mfma_f32_16x16x32_bf16 v[44:47], v[136:139], v[120:123], v[44:47]
    v_mfma_f32_16x16x32_bf16 v[60:63], v[120:123], v[140:143], v[60:63]
    s_waitcnt lgkmcnt(5)
    v_mfma_f32_16x16x32_bf16 v[48:51], v[136:139], v[124:127], v[48:51]
    v_mfma_f32_16x16x32_bf16 v[64:67], v[124:127], v[140:143], v[64:67]
    s_waitcnt lgkmcnt(4)
    v_mfma_f32_16x16x32_bf16 v[52:55], v[136:139], v[128:131], v[52:55]
    v_mfma_f32_16x16x32_bf16 v[68:71], v[128:131], v[140:143], v[68:71]
    s_waitcnt lgkmcnt(0)
    s_barrier
L_at_S1e_62:
    ds_read2_b32 v[88:89], v10 offset0:0 offset1:64
    ds_read2_b32 v[90:91], v10 offset0:16 offset1:80
    ds_read2_b32 v[92:93], v10 offset0:32 offset1:96
    ds_read2_b32 v[94:95], v10 offset0:48 offset1:112
    v_mfma_f32_16x16x32_bf16 v[72:75], v[132:135], v[208:211], v[72:75]
    ds_read_b128 v[96:99], v11 offset:0
    ds_read_b128 v[224:227], v11 offset:256
    v_mfma_f32_16x16x32_bf16 v[24:27], v[132:135], v[116:119], v[24:27]
    ds_read_b128 v[100:103], v11 offset:64
    ds_read_b128 v[228:231], v11 offset:320
    v_mfma_f32_16x16x32_bf16 v[28:31], v[132:135], v[120:123], v[28:31]
    ds_read_b128 v[104:107], v11 offset:128
    ds_read_b128 v[232:235], v11 offset:384
    v_mfma_f32_16x16x32_bf16 v[32:35], v[132:135], v[124:127], v[32:35]
    ds_read_b128 v[108:111], v11 offset:192
    ds_read_b128 v[236:239], v11 offset:448
    v_mfma_f32_16x16x32_bf16 v[36:39], v[132:135], v[128:131], v[36:39]
L_at_s1end_63:
    s_waitcnt lgkmcnt(8)
    v_mov_b32_dpp v76, v76 row_newbcast:0 row_mask:0xf bank_mask:0xf
    v_mov_b32_dpp v77, v77 row_newbcast:0 row_mask:0xf bank_mask:0xf
    v_mov_b32_dpp v78, v78 row_newbcast:0 row_mask:0xf bank_mask:0xf
    v_mov_b32_dpp v79, v79 row_newbcast:0 row_mask:0xf bank_mask:0xf
    v_pk_mul_f32 v[22:23], v[76:77], v[88:89] op_sel:[0,1] op_sel_hi:[1,1]
    v_pk_fma_f32 v[40:41], v[40:41], v[88:89], v[22:23] op_sel:[0,0,0] op_sel_hi:[1,0,1]
    v_pk_mul_f32 v[22:23], v[78:79], v[88:89] op_sel:[0,1] op_sel_hi:[1,1]
    v_pk_fma_f32 v[42:43], v[42:43], v[88:89], v[22:23] op_sel:[0,0,0] op_sel_hi:[1,0,1]
    v_pk_mul_f32 v[22:23], v[76:77], v[90:91] op_sel:[0,1] op_sel_hi:[1,1]
    v_pk_fma_f32 v[44:45], v[44:45], v[90:91], v[22:23] op_sel:[0,0,0] op_sel_hi:[1,0,1]
    v_pk_mul_f32 v[22:23], v[78:79], v[90:91] op_sel:[0,1] op_sel_hi:[1,1]
    v_pk_fma_f32 v[46:47], v[46:47], v[90:91], v[22:23] op_sel:[0,0,0] op_sel_hi:[1,0,1]
    v_pk_mul_f32 v[22:23], v[76:77], v[92:93] op_sel:[0,1] op_sel_hi:[1,1]
    v_pk_fma_f32 v[48:49], v[48:49], v[92:93], v[22:23] op_sel:[0,0,0] op_sel_hi:[1,0,1]
    v_pk_mul_f32 v[22:23], v[78:79], v[92:93] op_sel:[0,1] op_sel_hi:[1,1]
    v_pk_fma_f32 v[50:51], v[50:51], v[92:93], v[22:23] op_sel:[0,0,0] op_sel_hi:[1,0,1]
    v_pk_mul_f32 v[22:23], v[76:77], v[94:95] op_sel:[0,1] op_sel_hi:[1,1]
    v_pk_fma_f32 v[52:53], v[52:53], v[94:95], v[22:23] op_sel:[0,0,0] op_sel_hi:[1,0,1]
    v_pk_mul_f32 v[22:23], v[78:79], v[94:95] op_sel:[0,1] op_sel_hi:[1,1]
    v_pk_fma_f32 v[54:55], v[54:55], v[94:95], v[22:23] op_sel:[0,0,0] op_sel_hi:[1,0,1]
    v_cvt_pk_bf16_f32 v192, v40, v41
    v_cvt_pk_bf16_f32 v193, v42, v43
    v_cvt_pk_bf16_f32 v194, v44, v45
    v_cvt_pk_bf16_f32 v195, v46, v47
    v_cvt_pk_bf16_f32 v196, v48, v49
    v_cvt_pk_bf16_f32 v197, v50, v51
    v_cvt_pk_bf16_f32 v198, v52, v53
    v_cvt_pk_bf16_f32 v199, v54, v55
    v_permlane16_swap_b32 v192, v194
    v_permlane16_swap_b32 v193, v195
    v_permlane16_swap_b32 v196, v198
    v_permlane16_swap_b32 v197, v199
    buffer_store_dwordx4 v[192:195], v1, s[24:27], s4 offen offset:0 sc1
    buffer_store_dwordx4 v[196:199], v1, s[24:27], s4 offen offset:2048 sc1
    s_waitcnt lgkmcnt(0)
    v_pk_mul_f32 v[22:23], v[224:225], v[80:81] op_sel:[0,0] op_sel_hi:[1,0]
    v_pk_fma_f32 v[56:57], v[56:57], v[96:97], v[22:23]
    v_pk_mul_f32 v[22:23], v[226:227], v[80:81] op_sel:[0,0] op_sel_hi:[1,0]
    v_pk_fma_f32 v[58:59], v[58:59], v[98:99], v[22:23]
    v_pk_mul_f32 v[22:23], v[228:229], v[80:81] op_sel:[0,0] op_sel_hi:[1,0]
    v_pk_fma_f32 v[60:61], v[60:61], v[100:101], v[22:23]
    v_pk_mul_f32 v[22:23], v[230:231], v[80:81] op_sel:[0,0] op_sel_hi:[1,0]
    v_pk_fma_f32 v[62:63], v[62:63], v[102:103], v[22:23]
    v_pk_mul_f32 v[22:23], v[232:233], v[80:81] op_sel:[0,0] op_sel_hi:[1,0]
    v_pk_fma_f32 v[64:65], v[64:65], v[104:105], v[22:23]
    v_pk_mul_f32 v[22:23], v[234:235], v[80:81] op_sel:[0,0] op_sel_hi:[1,0]
    v_pk_fma_f32 v[66:67], v[66:67], v[106:107], v[22:23]
    v_pk_mul_f32 v[22:23], v[236:237], v[80:81] op_sel:[0,0] op_sel_hi:[1,0]
    v_pk_fma_f32 v[68:69], v[68:69], v[108:109], v[22:23]
    v_pk_mul_f32 v[22:23], v[238:239], v[80:81] op_sel:[0,0] op_sel_hi:[1,0]
    v_pk_fma_f32 v[70:71], v[70:71], v[110:111], v[22:23]
    v_cvt_pk_bf16_f32 v200, v56, v57
    v_cvt_pk_bf16_f32 v201, v58, v59
    v_cvt_pk_bf16_f32 v202, v60, v61
    v_cvt_pk_bf16_f32 v203, v62, v63
    v_cvt_pk_bf16_f32 v204, v64, v65
    v_cvt_pk_bf16_f32 v205, v66, v67
    v_cvt_pk_bf16_f32 v206, v68, v69
    v_cvt_pk_bf16_f32 v207, v70, v71
    v_permlane32_swap_b32 v200, v202
    v_permlane32_swap_b32 v201, v203
    v_permlane32_swap_b32 v204, v206
    v_permlane32_swap_b32 v205, v207
    buffer_store_dwordx4 v[200:203], v1, s[24:27], s4 offen offset:1024 sc1
    buffer_store_dwordx4 v[204:207], v1, s[24:27], s4 offen offset:3072 sc1
L_at_kvst_64:
    s_branch L_pg65
.p2align 12
L_pg65:
    ds_write_b128 v13, v[200:203] offset:50944
    ds_write_b128 v13, v[204:207] offset:53024
    s_mov_b64 exec, 3
    ds_write_b128 v13, v[84:87] offset:51968
    ds_write_b128 v13, v[84:87] offset:54048
    s_mov_b64 exec, -1
    ds_read_b128 v[220:223], v14 offset:49920
    ds_read_b128 v[224:227], v15 offset:49920
    ds_read_b128 v[228:231], v14 offset:52000
    ds_read_b128 v[232:235], v15 offset:52000
    s_mov_b64 exec, 0xffff
    ds_write_b128 v248, v[244:247] offset:2048
    s_mov_b64 exec, -1
    v_mul_f32 v88, 0x3eb8aa3b, v88
    v_mul_f32 v89, 0x3eb8aa3b, v89
    v_mul_f32 v90, 0x3eb8aa3b, v90
    v_mul_f32 v91, 0x3eb8aa3b, v91
    v_mul_f32 v92, 0x3eb8aa3b, v92
    v_mul_f32 v93, 0x3eb8aa3b, v93
    v_mul_f32 v94, 0x3eb8aa3b, v94
    v_mul_f32 v95, 0x3eb8aa3b, v95
    v_mov_b32_dpp v72, v72 row_newbcast:0 row_mask:0xf bank_mask:0xf
    v_mov_b32_dpp v73, v73 row_newbcast:0 row_mask:0xf bank_mask:0xf
    v_mov_b32_dpp v74, v74 row_newbcast:0 row_mask:0xf bank_mask:0xf
    v_mov_b32_dpp v75, v75 row_newbcast:0 row_mask:0xf bank_mask:0xf
    v_pk_mul_f32 v[22:23], v[72:73], v[88:89] op_sel:[0,1] op_sel_hi:[1,1]
    v_pk_fma_f32 v[24:25], v[24:25], v[88:89], v[22:23] op_sel:[0,0,0] op_sel_hi:[1,0,1]
    v_pk_mul_f32 v[22:23], v[74:75], v[88:89] op_sel:[0,1] op_sel_hi:[1,1]
    v_pk_fma_f32 v[26:27], v[26:27], v[88:89], v[22:23] op_sel:[0,0,0] op_sel_hi:[1,0,1]
    v_pk_mul_f32 v[22:23], v[72:73], v[90:91] op_sel:[0,1] op_sel_hi:[1,1]
    v_pk_fma_f32 v[28:29], v[28:29], v[90:91], v[22:23] op_sel:[0,0,0] op_sel_hi:[1,0,1]
    v_pk_mul_f32 v[22:23], v[74:75], v[90:91] op_sel:[0,1] op_sel_hi:[1,1]
    v_pk_fma_f32 v[30:31], v[30:31], v[90:91], v[22:23] op_sel:[0,0,0] op_sel_hi:[1,0,1]
    v_pk_mul_f32 v[22:23], v[72:73], v[92:93] op_sel:[0,1] op_sel_hi:[1,1]
    v_pk_fma_f32 v[32:33], v[32:33], v[92:93], v[22:23] op_sel:[0,0,0] op_sel_hi:[1,0,1]
    v_pk_mul_f32 v[22:23], v[74:75], v[92:93] op_sel:[0,1] op_sel_hi:[1,1]
    v_pk_fma_f32 v[34:35], v[34:35], v[92:93], v[22:23] op_sel:[0,0,0] op_sel_hi:[1,0,1]
    v_pk_mul_f32 v[22:23], v[72:73], v[94:95] op_sel:[0,1] op_sel_hi:[1,1]
    v_pk_fma_f32 v[36:37], v[36:37], v[94:95], v[22:23] op_sel:[0,0,0] op_sel_hi:[1,0,1]
    v_pk_mul_f32 v[22:23], v[74:75], v[94:95] op_sel:[0,1] op_sel_hi:[1,1]
    v_pk_fma_f32 v[38:39], v[38:39], v[94:95], v[22:23] op_sel:[0,0,0] op_sel_hi:[1,0,1]
    v_cvt_pk_bf16_f32 v184, v24, v25
    v_cvt_pk_bf16_f32 v185, v26, v27
    v_cvt_pk_bf16_f32 v186, v28, v29
    v_cvt_pk_bf16_f32 v187, v30, v31
    v_cvt_pk_bf16_f32 v188, v32, v33
    v_cvt_pk_bf16_f32 v189, v34, v35
    v_cvt_pk_bf16_f32 v190, v36, v37
    v_cvt_pk_bf16_f32 v191, v38, v39
    v_permlane16_swap_b32 v184, v186
    v_permlane16_swap_b32 v185, v187
    v_permlane16_swap_b32 v188, v190
    v_permlane16_swap_b32 v189, v191
    s_mov_b32 s68, 0
    s_waitcnt vmcnt(4)
L_np66:
    v_readfirstlane_b32 s52, v21
    v_readfirstlane_b32 s49, v20
    s_cmp_lg_u32 s52, 0
    s_cbranch_scc0 L_np66x
L_npd67:
    s_getreg_b32 s55, hwreg(HW_REG_XCC_ID, 0, 4)
    s_and_b32 s52, s49, -16
    s_or_b32 s55, s55, s52
    v_mov_b32 v21, s55
    s_mov_b64 exec, 1
    s_waitcnt vmcnt(0)
    buffer_store_dword v20, v2, s[24:27], s5 offen sc1
    buffer_store_dword v21, v2, s[24:27], s6 offen sc1
    s_mov_b64 exec, -1
L_at_flagA_68:
    v_mfma_f32_32x32x16_bf16 v[24:39], v[192:195], v[184:187], v[144:159]
    v_mfma_f32_32x32x16_bf16 v[40:55], v[192:195], v[188:191], 0
    s_nop 10
    v_exp_f32 v24, v24
    v_exp_f32 v25, v25
    v_exp_f32 v26, v26
    v_cvt_pk_bf16_f32 v96, v24, v25
    v_exp_f32 v27, v27
    v_exp_f32 v28, v28
    v_cvt_pk_bf16_f32 v97, v26, v27
    v_exp_f32 v29, v29
    v_exp_f32 v30, v30
    v_cvt_pk_bf16_f32 v98, v28, v29
    v_exp_f32 v31, v31
    v_exp_f32 v32, v32
    v_cvt_pk_bf16_f32 v99, v30, v31
    v_exp_f32 v33, v33
    v_exp_f32 v34, v34
    s_waitcnt lgkmcnt(3)
    v_mfma_f32_32x32x16_bf16 v[56:71], v[220:223], v[96:99], 0
    v_cvt_pk_bf16_f32 v100, v32, v33
    v_exp_f32 v35, v35
    v_exp_f32 v36, v36
    v_cvt_pk_bf16_f32 v101, v34, v35
    v_exp_f32 v37, v37
    v_exp_f32 v38, v38
    v_exp_f32 v39, v39
    v_cvt_pk_bf16_f32 v102, v36, v37
    v_cvt_pk_bf16_f32 v103, v38, v39
    v_mfma_f32_32x32x16_bf16 v[24:39], v[196:199], v[188:191], v[144:159]
    v_exp_f32 v40, v40
    v_exp_f32 v41, v41
    v_exp_f32 v42, v42
    v_cvt_pk_bf16_f32 v96, v40, v41
    v_exp_f32 v43, v43
    v_exp_f32 v44, v44
    v_cvt_pk_bf16_f32 v97, v42, v43
    v_mfma_f32_32x32x16_bf16 v[56:71], v[224:227], v[100:103], v[56:71]
    v_exp_f32 v45, v45
    v_exp_f32 v46, v46
    v_cvt_pk_bf16_f32 v98, v44, v45
    v_exp_f32 v47, v47
    v_exp_f32 v48, v48
    v_cvt_pk_bf16_f32 v99, v46, v47
    v_exp_f32 v49, v49
    v_exp_f32 v50, v50
    v_mfma_f32_32x32x16_bf16 v[72:87], v[220:223], v[96:99], 0
    v_cvt_pk_bf16_f32 v100, v48, v49
    v_exp_f32 v51, v51
    v_exp_f32 v52, v52
    v_cvt_pk_bf16_f32 v101, v50, v51
    v_exp_f32 v53, v53
    v_exp_f32 v54, v54
    v_exp_f32 v55, v55
    v_cvt_pk_bf16_f32 v102, v52, v53
    v_cvt_pk_bf16_f32 v103, v54, v55
    v_exp_f32 v24, v24
    v_exp_f32 v25, v25
    v_exp_f32 v26, v26
    v_cvt_pk_bf16_f32 v96, v24, v25
    v_exp_f32 v27, v27
    v_exp_f32 v28, v28
    v_cvt_pk_bf16_f32 v97, v26, v27
    v_mfma_f32_32x32x16_bf16 v[72:87], v[224:227], v[100:103], v[72:87]
    v_exp_f32 v29, v29
    v_exp_f32 v30, v30
    v_cvt_pk_bf16_f32 v98, v28, v29
    v_exp_f32 v31, v31
    v_exp_f32 v32, v32
    v_cvt_pk_bf16_f32 v99, v30, v31
    v_exp_f32 v33, v33
    v_exp_f32 v34, v34
    s_waitcnt lgkmcnt(1)
    v_mfma_f32_32x32x16_bf16 v[72:87], v[228:231], v[96:99], v[72:87]
    v_cvt_pk_bf16_f32 v100, v32, v33
    v_exp_f32 v35, v35
    v_exp_f32 v36, v36
    v_cvt_pk_bf16_f32 v101, v34, v35
    v_exp_f32 v37, v37
    v_exp_f32 v38, v38
    v_exp_f32 v39, v39
    v_cvt_pk_bf16_f32 v102, v36, v37
    v_cvt_pk_bf16_f32 v103, v38, v39
    s_nop 1
    v_mfma_f32_32x32x16_bf16 v[72:87], v[232:235], v[100:103], v[72:87]
    v_bfe_u32 v22, v0, 2, 3
    v_lshrrev_b32 v23, 5, v0
    v_lshl_add_u32 v22, v23, 4, v22
    v_lshlrev_b32 v22, 7, v22
    v_bfe_u32 v23, v0, 3, 2
    v_lshl_add_u32 v22, v23, 5, v22
    v_and_b32 v23, 3, v0
    v_lshl_add_u32 v22, v23, 3, v22
    v_add_u32 v4, 94208, v22
    v_xor_b32 v5, 32, v4
    v_xor_b32 v6, 64, v4
    v_xor_b32 v7, 96, v4
    v_and_b32 v8, 31, v0
    s_lshr_b32 s52, s46, 1
    s_lshl_b32 s52, s52, 7
    s_add_u32 s52, s52, s48
    s_add_u32 s52, s52, 479360
    v_lshl_add_u32 v8, v8, 2, s52
    v_lshrrev_b32 v104, 5, v0
    v_bfe_u32 v105, v0, 3, 2
    v_and_b32 v106, 7, v0
    v_bfe_u32 v107, v0, 4, 1
    v_lshlrev_b32 v107, 2, v107
    v_xor_b32 v106, v106, v107
    v_lshlrev_b32 v106, 4, v106
    v_lshl_add_u32 v106, v105, 10, v106
    s_mul_i32 s52, s46, 360448
    s_lshl_b32 s54, s45, 7
    s_add_u32 s52, s52, s54
    v_add_u32 v106, s52, v106
    v_lshl_add_u32 v9, v104, 14, v106
    v_lshl_add_u32 v10, v104, 12, v106
    s_mul_i32 s56, s46, 15360
    v_bfe_u32 v105, v0, 2, 2
    v_lshl_add_u32 v104, v104, 3, v105
    v_lshlrev_b32 v104, 7, v104
    v_bfe_u32 v105, v0, 3, 1
    v_lshl_add_u32 v104, v105, 6, v104
    v_bfe_u32 v105, v0, 4, 1
    v_lshl_add_u32 v104, v105, 5, v104
    v_and_b32 v105, 3, v0
    v_lshl_add_u32 v104, v105, 3, v104
    v_add_u32 v11, s56, v104
    v_xor_b32 v12, 64, v11
L_at_prePA_69:
    buffer_load_dword v22, v16, s[24:27], 0 offen sc1
    s_branch L_pg70
L_s3late:
    s_waitcnt vmcnt(0)
    s_mov_b64 exec, 1
    s_cbranch_vccz L_slow90
    buffer_store_dword v20, v2, s[24:27], s30 offen
L_join91:
    s_mov_b64 exec, -1
    s_waitcnt lgkmcnt(0)
    s_barrier
    ds_read_b64_tr_b16 v[80:81], v4 offset:0
    ds_read_b64_tr_b16 v[82:83], v4 offset:1024
    ds_read_b64_tr_b16 v[84:85], v5 offset:0
    ds_read_b64_tr_b16 v[86:87], v5 offset:1024
    ds_read_b64_tr_b16 v[88:89], v6 offset:0
    ds_read_b64_tr_b16 v[90:91], v6 offset:1024
    ds_read_b64_tr_b16 v[92:93], v7 offset:0
    ds_read_b64_tr_b16 v[94:95], v7 offset:1024
    ds_read_b64_tr_b16 v[96:97], v4 offset:4096
    ds_read_b64_tr_b16 v[98:99], v4 offset:5120
    ds_read_b64_tr_b16 v[100:101], v5 offset:4096
    ds_read_b64_tr_b16 v[102:103], v5 offset:5120
    ds_read_b64_tr_b16 v[104:105], v6 offset:4096
    ds_read_b64_tr_b16 v[106:107], v6 offset:5120
    ds_read_b64_tr_b16 v[108:109], v7 offset:4096
    ds_read_b64_tr_b16 v[110:111], v7 offset:5120
    ds_read_b64_tr_b16 v[112:113], v4 offset:8192
    ds_read_b64_tr_b16 v[114:115], v4 offset:9216
    ds_read_b64_tr_b16 v[116:117], v5 offset:8192
    ds_read_b64_tr_b16 v[118:119], v5 offset:9216
    ds_read_b64_tr_b16 v[120:121], v6 offset:8192
    ds_read_b64_tr_b16 v[122:123], v6 offset:9216
    ds_read_b64_tr_b16 v[124:125], v7 offset:8192
    ds_read_b64_tr_b16 v[126:127], v7 offset:9216
    ds_read_b64_tr_b16 v[128:129], v4 offset:12288
    ds_read_b64_tr_b16 v[130:131], v4 offset:13312
    ds_read_b64_tr_b16 v[132:133], v5 offset:12288
    ds_read_b64_tr_b16 v[134:135], v5 offset:13312
    ds_read_b64_tr_b16 v[136:137], v6 offset:12288
    ds_read_b64_tr_b16 v[138:139], v6 offset:13312
    ds_read_b64_tr_b16 v[140:141], v7 offset:12288
    ds_read_b64_tr_b16 v[142:143], v7 offset:13312
    buffer_load_dword v23, v8, s[24:27], 0 offen sc1
    ds_read_b64_tr_b16 v[144:145], v4 offset:16384
    ds_read_b64_tr_b16 v[146:147], v4 offset:17408
    ds_read_b64_tr_b16 v[148:149], v5 offset:16384
    ds_read_b64_tr_b16 v[150:151], v5 offset:17408
    ds_read_b64_tr_b16 v[152:153], v6 offset:16384
    ds_read_b64_tr_b16 v[154:155], v6 offset:17408
    ds_read_b64_tr_b16 v[156:157], v7 offset:16384
    ds_read_b64_tr_b16 v[158:159], v7 offset:17408
    ds_read_b64_tr_b16 v[160:161], v4 offset:20480
    ds_read_b64_tr_b16 v[162:163], v4 offset:21504
    ds_read_b64_tr_b16 v[164:165], v5 offset:20480
    ds_read_b64_tr_b16 v[166:167], v5 offset:21504
    ds_read_b64_tr_b16 v[168:169], v6 offset:20480
    ds_read_b64_tr_b16 v[170:171], v6 offset:21504
    ds_read_b64_tr_b16 v[172:173], v7 offset:20480
    ds_read_b64_tr_b16 v[174:175], v7 offset:21504
    ds_read_b64_tr_b16 v[176:177], v4 offset:24576
    ds_read_b64_tr_b16 v[178:179], v4 offset:25600
    ds_read_b64_tr_b16 v[180:181], v5 offset:24576
    ds_read_b64_tr_b16 v[182:183], v5 offset:25600
    ds_read_b64_tr_b16 v[184:185], v6 offset:24576
    ds_read_b64_tr_b16 v[186:187], v6 offset:25600
    ds_read_b64_tr_b16 v[188:189], v7 offset:24576
    ds_read_b64_tr_b16 v[190:191], v7 offset:25600
    s_mov_b32 s68, 0
    s_waitcnt vmcnt(0)
L_poll92:
    v_cmp_ne_u32 s[60:61], s49, v23
    s_nop 0
    s_cmp_lg_u64 s[60:61], 0
    s_cbranch_scc0 L_pdone93
    buffer_load_dword v23, v8, s[24:27], 0 offen sc1
    s_add_u32 s68, s68, 1
    s_cmp_lt_u32 s68, 200000
    s_waitcnt vmcnt(0)
    s_cbranch_scc1 L_poll92
L_pdone93:
    s_add_u32 s52, s31, s59
    s_add_u32 s59, s59, 4096
    s_and_b32 s59, s59, 0x3fff
    buffer_load_dwordx4 v[40:43], v1, s[24:27], s52 offen offset:0 sc1
    buffer_load_dwordx4 v[44:47], v1, s[24:27], s52 offen offset:1024 sc1
    buffer_load_dwordx4 v[48:51], v1, s[24:27], s52 offen offset:2048 sc1
    buffer_load_dwordx4 v[52:55], v1, s[24:27], s52 offen offset:3072 sc1
    s_add_u32 s52, s31, s59
    s_add_u32 s59, s59, 4096
    s_and_b32 s59, s59, 0x3fff
    buffer_load_dwordx4 v[56:59], v1, s[24:27], s52 offen offset:0 sc1
    buffer_load_dwordx4 v[60:63], v1, s[24:27], s52 offen offset:1024 sc1
    buffer_load_dwordx4 v[64:67], v1, s[24:27], s52 offen offset:2048 sc1
    buffer_load_dwordx4 v[68:71], v1, s[24:27], s52 offen offset:3072 sc1
    s_add_u32 s52, s31, s59
    s_add_u32 s59, s59, 4096
    s_and_b32 s59, s59, 0x3fff
    buffer_load_dwordx4 v[72:75], v1, s[24:27], s52 offen offset:0 sc1
    buffer_load_dwordx4 v[76:79], v1, s[24:27], s52 offen offset:1024 sc1
    ds_read_b64_tr_b16 v[192:193], v4 offset:28672
    ds_read_b64_tr_b16 v[194:195], v4 offset:29696
    ds_read_b64_tr_b16 v[196:197], v5 offset:28672
    ds_read_b64_tr_b16 v[198:199], v5 offset:29696
    ds_read_b64_tr_b16 v[200:201], v6 offset:28672
    ds_read_b64_tr_b16 v[202:203], v6 offset:29696
    ds_read_b64_tr_b16 v[204:205], v7 offset:28672
    ds_read_b64_tr_b16 v[206:207], v7 offset:29696
    ds_read_b64_tr_b16 v[208:209], v4 offset:32768
    ds_read_b64_tr_b16 v[210:211], v4 offset:33792
    ds_read_b64_tr_b16 v[212:213], v5 offset:32768
    ds_read_b64_tr_b16 v[214:215], v5 offset:33792
    ds_read_b64_tr_b16 v[216:217], v6 offset:32768
    ds_read_b64_tr_b16 v[218:219], v6 offset:33792
    ds_read_b64_tr_b16 v[220:221], v7 offset:32768
    ds_read_b64_tr_b16 v[222:223], v7 offset:33792
    ds_read_b64_tr_b16 v[224:225], v4 offset:36864
    ds_read_b64_tr_b16 v[226:227], v4 offset:37888
    ds_read_b64_tr_b16 v[228:229], v5 offset:36864
    ds_read_b64_tr_b16 v[230:231], v5 offset:37888
    ds_read_b64_tr_b16 v[232:233], v6 offset:36864
    ds_read_b64_tr_b16 v[234:235], v6 offset:37888
    ds_read_b64_tr_b16 v[236:237], v7 offset:36864
    ds_read_b64_tr_b16 v[238:239], v7 offset:37888
    ds_read_b64_tr_b16 v[240:241], v4 offset:40960
    ds_read_b64_tr_b16 v[242:243], v4 offset:41984
    ds_read_b64_tr_b16 v[244:245], v5 offset:40960
    ds_read_b64_tr_b16 v[246:247], v5 offset:41984
    ds_read_b64_tr_b16 v[248:249], v6 offset:40960
    ds_read_b64_tr_b16 v[250:251], v6 offset:41984
    ds_read_b64_tr_b16 v[252:253], v7 offset:40960
    ds_read_b64_tr_b16 v[254:255], v7 offset:41984
    s_waitcnt vmcnt(9) lgkmcnt(15)
    v_mfma_f32_16x16x32_bf16 v[24:27], v[80:83], v[40:43], v[24:27]
    v_mfma_f32_16x16x32_bf16 v[28:31], v[84:87], v[40:43], v[28:31]
    v_mfma_f32_16x16x32_bf16 v[32:35], v[88:91], v[40:43], v[32:35]
    v_mfma_f32_16x16x32_bf16 v[36:39], v[92:95], v[40:43], v[36:39]
    s_waitcnt vmcnt(8)
    v_mfma_f32_16x16x32_bf16 v[24:27], v[96:99], v[44:47], v[24:27]
    buffer_load_dwordx4 v[40:43], v1, s[24:27], s52 offen offset:2048 sc1
    ds_read_b64_tr_b16 v[80:81], v4 offset:45056
    ds_read_b64_tr_b16 v[82:83], v4 offset:46080
    v_mfma_f32_16x16x32_bf16 v[28:31], v[100:103], v[44:47], v[28:31]
    ds_read_b64_tr_b16 v[84:85], v5 offset:45056
    ds_read_b64_tr_b16 v[86:87], v5 offset:46080
    v_mfma_f32_16x16x32_bf16 v[32:35], v[104:107], v[44:47], v[32:35]
    ds_read_b64_tr_b16 v[88:89], v6 offset:45056
    ds_read_b64_tr_b16 v[90:91], v6 offset:46080
    v_mfma_f32_16x16x32_bf16 v[36:39], v[108:111], v[44:47], v[36:39]
    ds_read_b64_tr_b16 v[92:93], v7 offset:45056
    ds_read_b64_tr_b16 v[94:95], v7 offset:46080
    s_waitcnt vmcnt(8)
    v_mfma_f32_16x16x32_bf16 v[24:27], v[112:115], v[48:51], v[24:27]
    buffer_load_dwordx4 v[44:47], v1, s[24:27], s52 offen offset:3072 sc1
    ds_read_b64_tr_b16 v[96:97], v4 offset:49152
    ds_read_b64_tr_b16 v[98:99], v4 offset:50176
    v_mfma_f32_16x16x32_bf16 v[28:31], v[116:119], v[48:51], v[28:31]
    ds_read_b64_tr_b16 v[100:101], v5 offset:49152
    ds_read_b64_tr_b16 v[102:103], v5 offset:50176
    v_mfma_f32_16x16x32_bf16 v[32:35], v[120:123], v[48:51], v[32:35]
    ds_read_b64_tr_b16 v[104:105], v6 offset:49152
    ds_read_b64_tr_b16 v[106:107], v6 offset:50176
    v_mfma_f32_16x16x32_bf16 v[36:39], v[124:127], v[48:51], v[36:39]
    ds_read_b64_tr_b16 v[108:109], v7 offset:49152
    ds_read_b64_tr_b16 v[110:111], v7 offset:50176
    s_waitcnt vmcnt(8)
    v_mfma_f32_16x16x32_bf16 v[24:27], v[128:131], v[52:55], v[24:27]
    s_add_u32 s52, s31, s59
    s_add_u32 s59, s59, 4096
    s_and_b32 s59, s59, 0x3fff
    buffer_load_dwordx4 v[48:51], v1, s[24:27], s52 offen offset:0 sc1
    ds_read_b64_tr_b16 v[112:113], v4 offset:53248
    ds_read_b64_tr_b16 v[114:115], v4 offset:54272
    v_mfma_f32_16x16x32_bf16 v[28:31], v[132:135], v[52:55], v[28:31]
    ds_read_b64_tr_b16 v[116:117], v5 offset:53248
    ds_read_b64_tr_b16 v[118:119], v5 offset:54272
    v_mfma_f32_16x16x32_bf16 v[32:35], v[136:139], v[52:55], v[32:35]
    ds_read_b64_tr_b16 v[120:121], v6 offset:53248
    ds_read_b64_tr_b16 v[122:123], v6 offset:54272
    v_mfma_f32_16x16x32_bf16 v[36:39], v[140:143], v[52:55], v[36:39]
    ds_read_b64_tr_b16 v[124:125], v7 offset:53248
    ds_read_b64_tr_b16 v[126:127], v7 offset:54272
    s_waitcnt vmcnt(8)
    v_mfma_f32_16x16x32_bf16 v[24:27], v[144:147], v[56:59], v[24:27]
    buffer_load_dwordx4 v[52:55], v1, s[24:27], s52 offen offset:1024 sc1
    ds_read_b64_tr_b16 v[128:129], v4 offset:57344
    ds_read_b64_tr_b16 v[130:131], v4 offset:58368
    v_mfma_f32_16x16x32_bf16 v[28:31], v[148:151], v[56:59], v[28:31]
    ds_read_b64_tr_b16 v[132:133], v5 offset:57344
    ds_read_b64_tr_b16 v[134:135], v5 offset:58368
    v_mfma_f32_16x16x32_bf16 v[32:35], v[152:155], v[56:59], v[32:35]
    ds_read_b64_tr_b16 v[136:137], v6 offset:57344
    ds_read_b64_tr_b16 v[138:139], v6 offset:58368
    v_mfma_f32_16x16x32_bf16 v[36:39], v[156:159], v[56:59], v[36:39]
    ds_read_b64_tr_b16 v[140:141], v7 offset:57344
    ds_read_b64_tr_b16 v[142:143], v7 offset:58368
    s_waitcnt vmcnt(8)
    v_mfma_f32_16x16x32_bf16 v[24:27], v[160:163], v[60:63], v[24:27]
    buffer_load_dwordx4 v[56:59], v1, s[24:27], s52 offen offset:2048 sc1
    ds_read_b64_tr_b16 v[144:145], v4 offset:61440
    ds_read_b64_tr_b16 v[146:147], v4 offset:62464
    v_mfma_f32_16x16x32_bf16 v[28:31], v[164:167], v[60:63], v[28:31]
    ds_read_b64_tr_b16 v[148:149], v5 offset:61440
    ds_read_b64_tr_b16 v[150:151], v5 offset:62464
    v_mfma_f32_16x16x32_bf16 v[32:35], v[168:171], v[60:63], v[32:35]
    ds_read_b64_tr_b16 v[152:153], v6 offset:61440
    ds_read_b64_tr_b16 v[154:155], v6 offset:62464
    v_mfma_f32_16x16x32_bf16 v[36:39], v[172:175], v[60:63], v[36:39]
    ds_read_b64_tr_b16 v[156:157], v7 offset:61440
    ds_read_b64_tr_b16 v[158:159], v7 offset:62464
    s_waitcnt vmcnt(8)
    v_mfma_f32_16x16x32_bf16 v[24:27], v[176:179], v[64:67], v[24:27]
    buffer_load_dwordx4 v[60:63], v1, s[24:27], s52 offen offset:3072 sc1
    v_mfma_f32_16x16x32_bf16 v[28:31], v[180:183], v[64:67], v[28:31]
    v_mfma_f32_16x16x32_bf16 v[32:35], v[184:187], v[64:67], v[32:35]
    v_mfma_f32_16x16x32_bf16 v[36:39], v[188:191], v[64:67], v[36:39]
    s_waitcnt vmcnt(8)
    v_mfma_f32_16x16x32_bf16 v[24:27], v[192:195], v[68:71], v[24:27]
    v_mfma_f32_16x16x32_bf16 v[28:31], v[196:199], v[68:71], v[28:31]
    v_mfma_f32_16x16x32_bf16 v[32:35], v[200:203], v[68:71], v[32:35]
    v_mfma_f32_16x16x32_bf16 v[36:39], v[204:207], v[68:71], v[36:39]
    s_waitcnt vmcnt(7)
    v_mfma_f32_16x16x32_bf16 v[24:27], v[208:211], v[72:75], v[24:27]
    v_mfma_f32_16x16x32_bf16 v[28:31], v[212:215], v[72:75], v[28:31]
    v_mfma_f32_16x16x32_bf16 v[32:35], v[216:219], v[72:75], v[32:35]
    v_mfma_f32_16x16x32_bf16 v[36:39], v[220:223], v[72:75], v[36:39]
    s_waitcnt vmcnt(6) lgkmcnt(15)
    v_mfma_f32_16x16x32_bf16 v[24:27], v[224:227], v[76:79], v[24:27]
    v_mfma_f32_16x16x32_bf16 v[28:31], v[228:231], v[76:79], v[28:31]
    v_mfma_f32_16x16x32_bf16 v[32:35], v[232:235], v[76:79], v[32:35]
    v_mfma_f32_16x16x32_bf16 v[36:39], v[236:239], v[76:79], v[36:39]
    s_waitcnt vmcnt(5)
    v_mfma_f32_16x16x32_bf16 v[24:27], v[240:243], v[40:43], v[24:27]
    v_mfma_f32_16x16x32_bf16 v[28:31], v[244:247], v[40:43], v[28:31]
    v_mfma_f32_16x16x32_bf16 v[32:35], v[248:251], v[40:43], v[32:35]
    v_mfma_f32_16x16x32_bf16 v[36:39], v[252:255], v[40:43], v[36:39]
    s_waitcnt vmcnt(4)
    v_mfma_f32_16x16x32_bf16 v[24:27], v[80:83], v[44:47], v[24:27]
    v_mfma_f32_16x16x32_bf16 v[28:31], v[84:87], v[44:47], v[28:31]
    v_mfma_f32_16x16x32_bf16 v[32:35], v[88:91], v[44:47], v[32:35]
    v_mfma_f32_16x16x32_bf16 v[36:39], v[92:95], v[44:47], v[36:39]
    s_waitcnt vmcnt(3)
    v_mfma_f32_16x16x32_bf16 v[24:27], v[96:99], v[48:51], v[24:27]
    v_mfma_f32_16x16x32_bf16 v[28:31], v[100:103], v[48:51], v[28:31]
    v_mfma_f32_16x16x32_bf16 v[32:35], v[104:107], v[48:51], v[32:35]
    v_mfma_f32_16x16x32_bf16 v[36:39], v[108:111], v[48:51], v[36:39]
    s_waitcnt vmcnt(2)
    v_mfma_f32_16x16x32_bf16 v[24:27], v[112:115], v[52:55], v[24:27]
    v_mfma_f32_16x16x32_bf16 v[28:31], v[116:119], v[52:55], v[28:31]
    v_mfma_f32_16x16x32_bf16 v[32:35], v[120:123], v[52:55], v[32:35]
    v_mfma_f32_16x16x32_bf16 v[36:39], v[124:127], v[52:55], v[36:39]
    s_waitcnt vmcnt(1) lgkmcnt(8)
    v_mfma_f32_16x16x32_bf16 v[24:27], v[128:131], v[56:59], v[24:27]
    v_mfma_f32_16x16x32_bf16 v[28:31], v[132:135], v[56:59], v[28:31]
    v_mfma_f32_16x16x32_bf16 v[32:35], v[136:139], v[56:59], v[32:35]
    v_mfma_f32_16x16x32_bf16 v[36:39], v[140:143], v[56:59], v[36:39]
    s_waitcnt vmcnt(0) lgkmcnt(0)
    v_mfma_f32_16x16x32_bf16 v[24:27], v[144:147], v[60:63], v[24:27]
    v_mfma_f32_16x16x32_bf16 v[28:31], v[148:151], v[60:63], v[28:31]
    v_mfma_f32_16x16x32_bf16 v[32:35], v[152:155], v[60:63], v[32:35]
    v_mfma_f32_16x16x32_bf16 v[36:39], v[156:159], v[60:63], v[36:39]
    s_branch L_s3join
.p2align 12
L_pg70:
    s_mov_b32 s68, 0
    s_waitcnt vmcnt(0)
L_poll71:
    v_cmp_ne_u32 s[60:61], s49, v22
    s_nop 0
    s_and_b64 s[60:61], s[60:61], s[32:33]
    s_cbranch_scc0 L_pdone72
    buffer_load_dword v22, v16, s[24:27], 0 offen sc1
    s_add_u32 s68, s68, 1
    s_cmp_lt_u32 s68, 200000
    s_waitcnt vmcnt(0)
    s_cbranch_scc1 L_poll71
L_pdone72:
L_at_pollA_73:
    s_sub_u32 s52, s4, 524288
    s_cselect_b32 s52, 0x4000000, s52
    s_add_u32 s53, s52, 2048
    s_add_u32 m0, s69, 2080
    s_nop 0
    buffer_load_dwordx4 v1, s[24:27], s53 offen sc1 lds
    buffer_load_dwordx4 v1, s[24:27], s53 offen offset:1024 sc1 lds
    s_add_u32 m0, s69, 0
    s_nop 0
    buffer_load_dwordx4 v1, s[24:27], s52 offen sc1 lds
    buffer_load_dwordx4 v1, s[24:27], s52 offen offset:1024 sc1 lds
    s_sub_u32 s52, s4, 1048576
    s_cselect_b32 s52, 0x4000000, s52
    s_add_u32 s53, s52, 2048
    s_add_u32 m0, s69, 18720
    s_nop 0
    buffer_load_dwordx4 v1, s[24:27], s53 offen sc1 lds
    buffer_load_dwordx4 v1, s[24:27], s53 offen offset:1024 sc1 lds
    s_add_u32 m0, s69, 16640
    s_nop 0
    buffer_load_dwordx4 v1, s[24:27], s52 offen sc1 lds
    buffer_load_dwordx4 v1, s[24:27], s52 offen offset:1024 sc1 lds
    s_waitcnt vmcnt(6)
    ds_read_b128 v[208:211], v13 offset:2080
    ds_read_b128 v[220:223], v14 offset:2080
    ds_read_b128 v[224:227], v15 offset:2080
L_at_H0_74:
    s_mov_b32 s57, 0x28000000
    s_waitcnt lgkmcnt(2)
    v_mfma_f32_32x32x16_bf16 v[24:39], v[208:211], v[188:191], 0
    v_mfma_f32_32x32x16_bf16 v[40:55], v[208:211], v[184:187], 0
    s_sub_u32 s52, s4, 1572864
    s_cselect_b32 s52, 0x4000000, s52
    s_add_u32 s53, s52, 2048
    s_add_u32 m0, s69, 35360
    s_nop 0
    buffer_load_dwordx4 v1, s[24:27], s53 offen sc1 lds
    buffer_load_dwordx4 v1, s[24:27], s53 offen offset:1024 sc1 lds
    s_nop 3
    v_exp_f32 v24, v24
    v_exp_f32 v25, v25
    v_exp_f32 v26, v26
    v_cvt_pk_bf16_f32 v96, v24, v25
    v_exp_f32 v27, v27
    v_exp_f32 v28, v28
    v_cvt_pk_bf16_f32 v97, v26, v27
    s_waitcnt vmcnt(6)
    ds_read_b128 v[212:215], v13 offset:0
    ds_read_b128 v[228:231], v14 offset:0
    ds_read_b128 v[232:235], v15 offset:0
    v_exp_f32 v29, v29
    v_exp_f32 v30, v30
    v_cvt_pk_bf16_f32 v98, v28, v29
    v_exp_f32 v31, v31
    v_exp_f32 v32, v32
    v_cvt_pk_bf16_f32 v99, v30, v31
    v_exp_f32 v33, v33
    v_exp_f32 v34, v34
    s_waitcnt lgkmcnt(3)
    v_mfma_f32_32x32x16_bf16 v[72:87], v[220:223], v[96:99], v[72:87]
    v_cvt_pk_bf16_f32 v100, v32, v33
    v_exp_f32 v35, v35
    v_exp_f32 v36, v36
    v_cvt_pk_bf16_f32 v101, v34, v35
    v_exp_f32 v37, v37
    v_exp_f32 v38, v38
    v_exp_f32 v39, v39
    v_cvt_pk_bf16_f32 v102, v36, v37
    v_cvt_pk_bf16_f32 v103, v38, v39
    s_waitcnt lgkmcnt(2)
    v_mfma_f32_32x32x16_bf16 v[24:39], v[212:215], v[188:191], 0
    s_add_u32 m0, s69, 33280
    s_nop 0
    buffer_load_dwordx4 v1, s[24:27], s52 offen sc1 lds
    buffer_load_dwordx4 v1, s[24:27], s52 offen offset:1024 sc1 lds
    v_exp_f32 v40, v40
    v_exp_f32 v41, v41
    v_exp_f32 v42, v42
    v_cvt_pk_bf16_f32 v96, v40, v41
    v_exp_f32 v43, v43
    v_exp_f32 v44, v44
    v_cvt_pk_bf16_f32 v97, v42, v43
    v_mfma_f32_32x32x16_bf16 v[72:87], v[224:227], v[100:103], v[72:87]
    s_waitcnt vmcnt(6)
    ds_read_b128 v[216:219], v13 offset:18720
    ds_read_b128 v[236:239], v14 offset:18720
    ds_read_b128 v[240:243], v15 offset:18720
    v_exp_f32 v45, v45
    v_exp_f32 v46, v46
    v_cvt_pk_bf16_f32 v98, v44, v45
    v_exp_f32 v47, v47
    v_exp_f32 v48, v48
    v_cvt_pk_bf16_f32 v99, v46, v47
    v_exp_f32 v49, v49
    v_exp_f32 v50, v50
    v_mfma_f32_32x32x16_bf16 v[56:71], v[220:223], v[96:99], v[56:71]
    v_cvt_pk_bf16_f32 v100, v48, v49
    v_exp_f32 v51, v51
    v_exp_f32 v52, v52
    v_cvt_pk_bf16_f32 v101, v50, v51
    v_exp_f32 v53, v53
    v_exp_f32 v54, v54
    v_exp_f32 v55, v55
    v_cvt_pk_bf16_f32 v102, v52, v53
    v_cvt_pk_bf16_f32 v103, v54, v55
    s_waitcnt lgkmcnt(2)
    v_mfma_f32_32x32x16_bf16 v[40:55], v[216:219], v[188:191], 0
    s_sub_u32 s52, s4, 2097152
    s_cselect_b32 s52, 0x4000000, s52
    s_add_u32 s53, s52, 2048
    s_add_u32 m0, s69, 52000
    s_nop 0
    buffer_load_dwordx4 v1, s[24:27], s53 offen sc1 lds
    buffer_load_dwordx4 v1, s[24:27], s53 offen offset:1024 sc1 lds
    v_exp_f32 v24, v24
    v_exp_f32 v25, v25
    v_exp_f32 v26, v26
    v_cvt_pk_bf16_f32 v96, v24, v25
    v_exp_f32 v27, v27
    v_exp_f32 v28, v28
    v_cvt_pk_bf16_f32 v97, v26, v27
    v_mfma_f32_32x32x16_bf16 v[56:71], v[224:227], v[100:103], v[56:71]
    s_waitcnt vmcnt(6)
    ds_read_b128 v[208:211], v13 offset:16640
    ds_read_b128 v[220:223], v14 offset:16640
    ds_read_b128 v[224:227], v15 offset:16640
    v_exp_f32 v29, v29
    v_exp_f32 v30, v30
    v_cvt_pk_bf16_f32 v98, v28, v29
    v_exp_f32 v31, v31
    v_exp_f32 v32, v32
    v_cvt_pk_bf16_f32 v99, v30, v31
    v_exp_f32 v33, v33
    v_exp_f32 v34, v34
    v_mfma_f32_32x32x16_bf16 v[72:87], v[228:231], v[96:99], v[72:87]
    v_cvt_pk_bf16_f32 v100, v32, v33
    v_exp_f32 v35, v35
    v_exp_f32 v36, v36
    v_cvt_pk_bf16_f32 v101, v34, v35
    v_exp_f32 v37, v37
    v_exp_f32 v38, v38
    v_exp_f32 v39, v39
    v_cvt_pk_bf16_f32 v102, v36, v37
    v_cvt_pk_bf16_f32 v103, v38, v39
    s_waitcnt lgkmcnt(2)
    v_mfma_f32_32x32x16_bf16 v[24:39], v[208:211], v[188:191], 0
    s_add_u32 m0, s69, 49920
    s_nop 0
    buffer_load_dwordx4 v1, s[24:27], s52 offen sc1 lds
    buffer_load_dwordx4 v1, s[24:27], s52 offen offset:1024 sc1 lds
    v_exp_f32 v40, v40
    v_exp_f32 v41, v41
    v_exp_f32 v42, v42
    v_cvt_pk_bf16_f32 v96, v40, v41
    v_exp_f32 v43, v43
    v_exp_f32 v44, v44
    v_cvt_pk_bf16_f32 v97, v42, v43
    v_mfma_f32_32x32x16_bf16 v[72:87], v[232:235], v[100:103], v[72:87]
    s_waitcnt vmcnt(6)
    ds_read_b128 v[212:215], v13 offset:35360
    ds_read_b128 v[228:231], v14 offset:35360
    ds_read_b128 v[232:235], v15 offset:35360
    v_exp_f32 v45, v45
    v_exp_f32 v46, v46
    v_cvt_pk_bf16_f32 v98, v44, v45
    v_exp_f32 v47, v47
    v_exp_f32 v48, v48
    v_cvt_pk_bf16_f32 v99, v46, v47
    v_exp_f32 v49, v49
    v_exp_f32 v50, v50
    v_mfma_f32_32x32x16_bf16 v[72:87], v[236:239], v[96:99], v[72:87]
    v_cvt_pk_bf16_f32 v100, v48, v49
    v_exp_f32 v51, v51
    v_exp_f32 v52, v52
    v_cvt_pk_bf16_f32 v101, v50, v51
    v_exp_f32 v53, v53
    v_exp_f32 v54, v54
    v_exp_f32 v55, v55
    v_cvt_pk_bf16_f32 v102, v52, v53
    v_cvt_pk_bf16_f32 v103, v54, v55
    s_waitcnt lgkmcnt(2)
    v_mfma_f32_32x32x16_bf16 v[40:55], v[212:215], v[188:191], 0
    buffer_load_dword v19, v17, s[24:27], 0 offen sc1
    v_exp_f32 v24, v24
    v_exp_f32 v25, v25
    v_exp_f32 v26, v26
    v_cvt_pk_bf16_f32 v96, v24, v25
    v_exp_f32 v27, v27
    v_exp_f32 v28, v28
    v_cvt_pk_bf16_f32 v97, v26, v27
    v_mfma_f32_32x32x16_bf16 v[72:87], v[240:243], v[100:103], v[72:87]
    s_waitcnt vmcnt(5)
    ds_read_b128 v[216:219], v13 offset:33280
    ds_read_b128 v[236:239], v14 offset:33280
    ds_read_b128 v[240:243], v15 offset:33280
    v_exp_f32 v29, v29
    v_exp_f32 v30, v30
    v_cvt_pk_bf16_f32 v98, v28, v29
    v_exp_f32 v31, v31
    v_exp_f32 v32, v32
    v_cvt_pk_bf16_f32 v99, v30, v31
    v_exp_f32 v33, v33
    v_exp_f32 v34, v34
    v_mfma_f32_32x32x16_bf16 v[72:87], v[220:223], v[96:99], v[72:87]
    v_cvt_pk_bf16_f32 v100, v32, v33
    v_exp_f32 v35, v35
    v_exp_f32 v36, v36
    v_cvt_pk_bf16_f32 v101, v34, v35
    v_exp_f32 v37, v37
    v_exp_f32 v38, v38
    v_exp_f32 v39, v39
    v_cvt_pk_bf16_f32 v102, v36, v37
    v_cvt_pk_bf16_f32 v103, v38, v39
    s_waitcnt lgkmcnt(2)
    v_mfma_f32_32x32x16_bf16 v[24:39], v[216:219], v[188:191], 0
    v_exp_f32 v40, v40
    v_exp_f32 v41, v41
    v_exp_f32 v42, v42
    v_cvt_pk_bf16_f32 v96, v40, v41
    v_exp_f32 v43, v43
    v_exp_f32 v44, v44
    v_cvt_pk_bf16_f32 v97, v42, v43
    v_mfma_f32_32x32x16_bf16 v[72:87], v[224:227], v[100:103], v[72:87]
    s_waitcnt vmcnt(3)
    ds_read_b128 v[208:211], v13 offset:52000
    ds_read_b128 v[220:223], v14 offset:52000
    ds_read_b128 v[224:227], v15 offset:52000
    v_exp_f32 v45, v45
    v_exp_f32 v46, v46
    v_cvt_pk_bf16_f32 v98, v44, v45
    v_exp_f32 v47, v47
    v_exp_f32 v48, v48
    v_cvt_pk_bf16_f32 v99, v46, v47
    v_exp_f32 v49, v49
    v_exp_f32 v50, v50
    v_mfma_f32_32x32x16_bf16 v[72:87], v[228:231], v[96:99], v[72:87]
    v_cvt_pk_bf16_f32 v100, v48, v49
    v_exp_f32 v51, v51
    v_exp_f32 v52, v52
    v_cvt_pk_bf16_f32 v101, v50, v51
    v_exp_f32 v53, v53
    v_exp_f32 v54, v54
    v_exp_f32 v55, v55
    v_cvt_pk_bf16_f32 v102, v52, v53
    v_cvt_pk_bf16_f32 v103, v54, v55
    s_waitcnt lgkmcnt(2)
    v_mfma_f32_32x32x16_bf16 v[40:55], v[208:211], v[188:191], v[160:175]
    v_exp_f32 v24, v24
    v_exp_f32 v25, v25
    v_exp_f32 v26, v26
    v_cvt_pk_bf16_f32 v96, v24, v25
    v_exp_f32 v27, v27
    v_exp_f32 v28, v28
    v_cvt_pk_bf16_f32 v97, v26, v27
    v_mfma_f32_32x32x16_bf16 v[72:87], v[232:235], v[100:103], v[72:87]
    ds_read_b128 v[212:215], v13 offset:0
    ds_read_b128 v[228:231], v14 offset:0
    ds_read_b128 v[232:235], v15 offset:0
    v_exp_f32 v29, v29
    v_exp_f32 v30, v30
    v_cvt_pk_bf16_f32 v98, v28, v29
    v_exp_f32 v31, v31
    v_exp_f32 v32, v32
    v_cvt_pk_bf16_f32 v99, v30, v31
    v_exp_f32 v33, v33
    v_exp_f32 v34, v34
    v_mfma_f32_32x32x16_bf16 v[72:87], v[236:239], v[96:99], v[72:87]
    v_cvt_pk_bf16_f32 v100, v32, v33
    v_exp_f32 v35, v35
    v_exp_f32 v36, v36
    v_cvt_pk_bf16_f32 v101, v34, v35
    v_exp_f32 v37, v37
    v_exp_f32 v38, v38
    v_exp_f32 v39, v39
    v_cvt_pk_bf16_f32 v102, v36, v37
    v_cvt_pk_bf16_f32 v103, v38, v39
    s_waitcnt lgkmcnt(2)
    v_mfma_f32_32x32x16_bf16 v[24:39], v[212:215], v[184:187], 0
    v_exp_f32 v40, v40
    v_exp_f32 v41, v41
    v_exp_f32 v42, v42
    v_cvt_pk_bf16_f32 v96, v40, v41
    v_exp_f32 v43, v43
    v_exp_f32 v44, v44
    v_cvt_pk_bf16_f32 v97, v42, v43
    v_mfma_f32_32x32x16_bf16 v[72:87], v[240:243], v[100:103], v[72:87]
    ds_read_b128 v[216:219], v13 offset:18720
    ds_read_b128 v[236:239], v14 offset:18720
    ds_read_b128 v[240:243], v15 offset:18720
    v_exp_f32 v45, v45
    v_exp_f32 v46, v46
    v_cvt_pk_bf16_f32 v98, v44, v45
    v_exp_f32 v47, v47
    v_exp_f32 v48, v48
    v_cvt_pk_bf16_f32 v99, v46, v47
    v_exp_f32 v49, v49
    v_exp_f32 v50, v50
    v_mfma_f32_32x32x16_bf16 v[72:87], v[220:223], v[96:99], v[72:87]
    v_cvt_pk_bf16_f32 v100, v48, v49
    v_exp_f32 v51, v51
    v_exp_f32 v52, v52
    v_cvt_pk_bf16_f32 v101, v50, v51
    v_exp_f32 v53, v53
    v_exp_f32 v54, v54
    v_exp_f32 v55, v55
    v_cvt_pk_bf16_f32 v102, v52, v53
    v_cvt_pk_bf16_f32 v103, v54, v55
    s_waitcnt lgkmcnt(2)
    v_mfma_f32_32x32x16_bf16 v[40:55], v[216:219], v[184:187], 0
    v_exp_f32 v24, v24
    v_exp_f32 v25, v25
    v_exp_f32 v26, v26
    v_cvt_pk_bf16_f32 v96, v24, v25
    v_exp_f32 v27, v27
    v_exp_f32 v28, v28
    v_cvt_pk_bf16_f32 v97, v26, v27
    v_mfma_f32_32x32x16_bf16 v[72:87], v[224:227], v[100:103], v[72:87]
    ds_read_b128 v[208:211], v13 offset:16640
    ds_read_b128 v[220:223], v14 offset:16640
    ds_read_b128 v[224:227], v15 offset:16640
    v_exp_f32 v29, v29
    v_exp_f32 v30, v30
    v_cvt_pk_bf16_f32 v98, v28, v29
    v_exp_f32 v31, v31
    v_exp_f32 v32, v32
    v_cvt_pk_bf16_f32 v99, v30, v31
    v_exp_f32 v33, v33
    v_exp_f32 v34, v34
    v_mfma_f32_32x32x16_bf16 v[56:71], v[228:231], v[96:99], v[56:71]
    v_cvt_pk_bf16_f32 v100, v32, v33
    v_exp_f32 v35, v35
    v_exp_f32 v36, v36
    v_cvt_pk_bf16_f32 v101, v34, v35
    v_exp_f32 v37, v37
    v_exp_f32 v38, v38
    v_exp_f32 v39, v39
    v_cvt_pk_bf16_f32 v102, v36, v37
    v_cvt_pk_bf16_f32 v103, v38, v39
    s_waitcnt lgkmcnt(2)
    v_mfma_f32_32x32x16_bf16 v[24:39], v[208:211], v[184:187], 0
    s_mov_b32 s68, 0
    s_waitcnt vmcnt(0)
L_xp75:
    v_xor_b32 v22, s55, v19
    v_cmp_le_u32 s[60:61], 16, v22
    v_cmp_ne_u32 s[62:63], 0, v22
    s_and_b32 s60, s60, 0xff
    s_cbranch_scc1 L_xp75x
L_xpd76:
    s_and_b32 s62, s62, 0xff
    s_cselect_b64 vcc, 0, -1
    v_subrev_u32 v22, 0x2b800000, v80
    v_cmp_le_u32 s[60:61], s57, v22
    s_nop 0
    s_cmp_lg_u64 s[60:61], 0
    s_cbranch_scc1 L_fallback1
L_fb_done1:
    v_rcp_f32 v80, v80
    s_nop 0
    v_mul_f32 v72, v72, v80
    v_mul_f32 v73, v73, v80
    v_mul_f32 v74, v74, v80
    v_mul_f32 v75, v75, v80
    v_mul_f32 v76, v76, v80
    v_mul_f32 v77, v77, v80
    v_mul_f32 v78, v78, v80
    v_mul_f32 v79, v79, v80
    v_cvt_pk_bf16_f32 v92, v72, v73
    v_cvt_pk_bf16_f32 v93, v74, v75
    v_cvt_pk_bf16_f32 v94, v76, v77
    v_cvt_pk_bf16_f32 v95, v78, v79
    buffer_store_dwordx4 v[92:95], v18, s[24:27], s29 offen sc1
    v_exp_f32 v40, v40
    v_exp_f32 v41, v41
    v_exp_f32 v42, v42
    v_cvt_pk_bf16_f32 v96, v40, v41
    v_exp_f32 v43, v43
    v_exp_f32 v44, v44
    v_cvt_pk_bf16_f32 v97, v42, v43
    v_mfma_f32_32x32x16_bf16 v[56:71], v[232:235], v[100:103], v[56:71]
    ds_read_b128 v[212:215], v13 offset:35360
    ds_read_b128 v[228:231], v14 offset:35360
    ds_read_b128 v[232:235], v15 offset:35360
    v_exp_f32 v45, v45
    v_exp_f32 v46, v46
    v_cvt_pk_bf16_f32 v98, v44, v45
    v_exp_f32 v47, v47
    v_exp_f32 v48, v48
    v_cvt_pk_bf16_f32 v99, v46, v47
    v_exp_f32 v49, v49
    v_exp_f32 v50, v50
    v_mfma_f32_32x32x16_bf16 v[56:71], v[236:239], v[96:99], v[56:71]
    v_cvt_pk_bf16_f32 v100, v48, v49
    v_exp_f32 v51, v51
    v_exp_f32 v52, v52
    v_cvt_pk_bf16_f32 v101, v50, v51
    v_exp_f32 v53, v53
    v_exp_f32 v54, v54
    v_exp_f32 v55, v55
    v_cvt_pk_bf16_f32 v102, v52, v53
    v_cvt_pk_bf16_f32 v103, v54, v55
    s_waitcnt lgkmcnt(2)
    v_mfma_f32_32x32x16_bf16 v[40:55], v[212:215], v[184:187], 0
    v_exp_f32 v24, v24
    v_exp_f32 v25, v25
    v_exp_f32 v26, v26
    v_cvt_pk_bf16_f32 v96, v24, v25
    v_exp_f32 v27, v27
    v_exp_f32 v28, v28
    v_cvt_pk_bf16_f32 v97, v26, v27
    v_mfma_f32_32x32x16_bf16 v[56:71], v[240:243], v[100:103], v[56:71]
    ds_read_b128 v[216:219], v13 offset:33280
    ds_read_b128 v[236:239], v14 offset:33280
    ds_read_b128 v[240:243], v15 offset:33280
    v_exp_f32 v29, v29
    v_exp_f32 v30, v30
    v_cvt_pk_bf16_f32 v98, v28, v29
    v_exp_f32 v31, v31
    v_exp_f32 v32, v32
    v_cvt_pk_bf16_f32 v99, v30, v31
    v_exp_f32 v33, v33
    v_exp_f32 v34, v34
    v_mfma_f32_32x32x16_bf16 v[56:71], v[220:223], v[96:99], v[56:71]
    v_cvt_pk_bf16_f32 v100, v32, v33
    v_exp_f32 v35, v35
    v_exp_f32 v36, v36
    v_cvt_pk_bf16_f32 v101, v34, v35
    v_exp_f32 v37, v37
    v_exp_f32 v38, v38
    v_exp_f32 v39, v39
    v_cvt_pk_bf16_f32 v102, v36, v37
    v_cvt_pk_bf16_f32 v103, v38, v39
    s_waitcnt lgkmcnt(2)
    v_mfma_f32_32x32x16_bf16 v[24:39], v[216:219], v[184:187], 0
    v_exp_f32 v40, v40
    v_exp_f32 v41, v41
    v_exp_f32 v42, v42
    v_cvt_pk_bf16_f32 v96, v40, v41
    v_exp_f32 v43, v43
    v_exp_f32 v44, v44
    v_cvt_pk_bf16_f32 v97, v42, v43
    v_mfma_f32_32x32x16_bf16 v[56:71], v[224:227], v[100:103], v[56:71]
    ds_read_b128 v[208:211], v13 offset:52000
    ds_read_b128 v[220:223], v14 offset:52000
    ds_read_b128 v[224:227], v15 offset:52000
    v_exp_f32 v45, v45
    v_exp_f32 v46, v46
    v_cvt_pk_bf16_f32 v98, v44, v45
    v_exp_f32 v47, v47
    v_exp_f32 v48, v48
    v_cvt_pk_bf16_f32 v99, v46, v47
    v_exp_f32 v49, v49
    v_exp_f32 v50, v50
    v_mfma_f32_32x32x16_bf16 v[56:71], v[228:231], v[96:99], v[56:71]
    v_cvt_pk_bf16_f32 v100, v48, v49
    v_exp_f32 v51, v51
    v_exp_f32 v52, v52
    v_cvt_pk_bf16_f32 v101, v50, v51
    v_exp_f32 v53, v53
    v_exp_f32 v54, v54
    v_exp_f32 v55, v55
    v_cvt_pk_bf16_f32 v102, v52, v53
    v_cvt_pk_bf16_f32 v103, v54, v55
    s_waitcnt lgkmcnt(2)
    v_mfma_f32_32x32x16_bf16 v[40:55], v[208:211], v[184:187], 0
    v_exp_f32 v24, v24
    v_exp_f32 v25, v25
    v_exp_f32 v26, v26
    v_cvt_pk_bf16_f32 v96, v24, v25
    v_exp_f32 v27, v27
    v_exp_f32 v28, v28
    v_cvt_pk_bf16_f32 v97, v26, v27
    v_mfma_f32_32x32x16_bf16 v[56:71], v[232:235], v[100:103], v[56:71]
    ds_read_b128 v[212:215], v13 offset:49920
    ds_read_b128 v[228:231], v14 offset:49920
    ds_read_b128 v[232:235], v15 offset:49920
    v_exp_f32 v29, v29
    v_exp_f32 v30, v30
    v_cvt_pk_bf16_f32 v98, v28, v29
    v_exp_f32 v31, v31
    v_exp_f32 v32, v32
    v_cvt_pk_bf16_f32 v99, v30, v31
    v_exp_f32 v33, v33
    v_exp_f32 v34, v34
    v_mfma_f32_32x32x16_bf16 v[56:71], v[236:239], v[96:99], v[56:71]
    v_cvt_pk_bf16_f32 v100, v32, v33
    v_exp_f32 v35, v35
    v_exp_f32 v36, v36
    v_cvt_pk_bf16_f32 v101, v34, v35
    v_exp_f32 v37, v37
    v_exp_f32 v38, v38
    v_exp_f32 v39, v39
    v_cvt_pk_bf16_f32 v102, v36, v37
    v_cvt_pk_bf16_f32 v103, v38, v39
    s_waitcnt lgkmcnt(2)
    v_mfma_f32_32x32x16_bf16 v[24:39], v[212:215], v[184:187], v[160:175]
    s_waitcnt vmcnt(0)
    s_mov_b64 exec, 1
    s_cbranch_vccz L_slow77
    buffer_store_dword v20, v2, s[24:27], s30 offen offset:128
L_join78:
    s_mov_b64 exec, -1
L_at_flagB1_79:
    v_exp_f32 v40, v40
    v_exp_f32 v41, v41
    v_exp_f32 v42, v42
    v_cvt_pk_bf16_f32 v96, v40, v41
    v_exp_f32 v43, v43
    v_exp_f32 v44, v44
    v_cvt_pk_bf16_f32 v97, v42, v43
    v_mfma_f32_32x32x16_bf16 v[56:71], v[240:243], v[100:103], v[56:71]
    v_exp_f32 v45, v45
    v_exp_f32 v46, v46
    v_cvt_pk_bf16_f32 v98, v44, v45
    v_exp_f32 v47, v47
    v_exp_f32 v48, v48
    v_cvt_pk_bf16_f32 v99, v46, v47
    v_exp_f32 v49, v49
    v_exp_f32 v50, v50
    v_mfma_f32_32x32x16_bf16 v[56:71], v[220:223], v[96:99], v[56:71]
    v_cvt_pk_bf16_f32 v100, v48, v49
    v_exp_f32 v51, v51
    v_exp_f32 v52, v52
    v_cvt_pk_bf16_f32 v101, v50, v51
    v_exp_f32 v53, v53
    v_exp_f32 v54, v54
    v_exp_f32 v55, v55
    v_cvt_pk_bf16_f32 v102, v52, v53
    v_cvt_pk_bf16_f32 v103, v54, v55
    v_exp_f32 v24, v24
    v_exp_f32 v25, v25
    v_exp_f32 v26, v26
    v_cvt_pk_bf16_f32 v96, v24, v25
    v_exp_f32 v27, v27
    v_exp_f32 v28, v28
    v_cvt_pk_bf16_f32 v97, v26, v27
    v_mfma_f32_32x32x16_bf16 v[56:71], v[224:227], v[100:103], v[56:71]
    v_exp_f32 v29, v29
    v_exp_f32 v30, v30
    v_cvt_pk_bf16_f32 v98, v28, v29
    v_exp_f32 v31, v31
    v_exp_f32 v32, v32
    v_cvt_pk_bf16_f32 v99, v30, v31
    v_exp_f32 v33, v33
    v_exp_f32 v34, v34
    s_waitcnt lgkmcnt(0)
    v_mfma_f32_32x32x16_bf16 v[56:71], v[228:231], v[96:99], v[56:71]
    v_cvt_pk_bf16_f32 v100, v32, v33
    v_exp_f32 v35, v35
    v_exp_f32 v36, v36
    v_cvt_pk_bf16_f32 v101, v34, v35
    v_exp_f32 v37, v37
    v_exp_f32 v38, v38
    v_exp_f32 v39, v39
    v_cvt_pk_bf16_f32 v102, v36, v37
    v_cvt_pk_bf16_f32 v103, v38, v39
    s_nop 1
    v_mfma_f32_32x32x16_bf16 v[56:71], v[232:235], v[100:103], v[56:71]
L_at_attend_80:
    buffer_load_dword v23, v8, s[24:27], 0 offen sc1
    s_nop 10
    v_subrev_u32 v22, 0x2b800000, v64
    v_cmp_le_u32 s[60:61], s57, v22
    s_nop 0
    s_cmp_lg_u64 s[60:61], 0
    s_cbranch_scc1 L_fallback0
L_fb_done0:
    v_rcp_f32 v64, v64
    s_nop 0
    v_pk_mul_f32 v[56:57], v[56:57], v[64:65] op_sel:[0,0] op_sel_hi:[1,0]
    v_pk_mul_f32 v[58:59], v[58:59], v[64:65] op_sel:[0,0] op_sel_hi:[1,0]
    v_pk_mul_f32 v[60:61], v[60:61], v[64:65] op_sel:[0,0] op_sel_hi:[1,0]
    v_pk_mul_f32 v[62:63], v[62:63], v[64:65] op_sel:[0,0] op_sel_hi:[1,0]
    v_cvt_pk_bf16_f32 v40, v56, v57
    v_cvt_pk_bf16_f32 v41, v58, v59
    v_cvt_pk_bf16_f32 v42, v60, v61
    v_cvt_pk_bf16_f32 v43, v62, v63
    buffer_store_dwordx4 v[40:43], v18, s[24:27], s28 offen sc1
    v_mov_b32 v22, 160256
    v_mov_b32 v21, vcc_lo
    ds_write_b64 v22, v[20:21]
    v_lshlrev_b32 v24, 16, v176
    v_and_b32 v25, 0xffff0000, v176
    v_lshlrev_b32 v26, 16, v177
    v_and_b32 v27, 0xffff0000, v177
    v_lshlrev_b32 v28, 16, v178
    v_and_b32 v29, 0xffff0000, v178
    v_lshlrev_b32 v30, 16, v179
    v_and_b32 v31, 0xffff0000, v179
    v_lshlrev_b32 v32, 16, v180
    v_and_b32 v33, 0xffff0000, v180
    v_lshlrev_b32 v34, 16, v181
    v_and_b32 v35, 0xffff0000, v181
    v_lshlrev_b32 v36, 16, v182
    v_and_b32 v37, 0xffff0000, v182
    v_lshlrev_b32 v38, 16, v183
    v_and_b32 v39, 0xffff0000, v183
    s_lshl_b32 s59, s51, 10
    s_mov_b32 s69, s56
    s_cmp_lt_u32 s46, 2
    s_cbranch_scc1 L_s3late
    s_mov_b32 s68, 0
    s_waitcnt vmcnt(1)
L_poll81:
    v_cmp_ne_u32 s[60:61], s49, v23
    s_nop 0
    s_cmp_lg_u64 s[60:61], 0
    s_cbranch_scc0 L_pdone82
    s_cmp_lg_u32 s68, 0
    s_cbranch_scc1 L_poll81y
    s_waitcnt vmcnt(0)
    s_mov_b64 exec, 1
    s_cbranch_vccz L_slow83
    buffer_store_dword v20, v2, s[24:27], s30 offen
L_join84:
    s_mov_b64 exec, -1
L_poll81y:
    buffer_load_dword v23, v8, s[24:27], 0 offen sc1
    s_add_u32 s68, s68, 1
    s_cmp_lt_u32 s68, 200000
    s_waitcnt vmcnt(0)
    s_cbranch_scc1 L_poll81
L_pdone82:
L_at_pollB_85:
    s_add_u32 s52, s31, s59
    s_add_u32 s59, s59, 4096
    s_and_b32 s59, s59, 0x3fff
    buffer_load_dwordx4 v[40:43], v1, s[24:27], s52 offen offset:0 sc1
    buffer_load_dwordx4 v[44:47], v1, s[24:27], s52 offen offset:1024 sc1
    buffer_load_dwordx4 v[48:51], v1, s[24:27], s52 offen offset:2048 sc1
    buffer_load_dwordx4 v[52:55], v1, s[24:27], s52 offen offset:3072 sc1
    s_add_u32 s52, s31, s59
    s_add_u32 s59, s59, 4096
    s_and_b32 s59, s59, 0x3fff
    buffer_load_dwordx4 v[56:59], v1, s[24:27], s52 offen offset:0 sc1
    buffer_load_dwordx4 v[60:63], v1, s[24:27], s52 offen offset:1024 sc1
    buffer_load_dwordx4 v[64:67], v1, s[24:27], s52 offen offset:2048 sc1
    buffer_load_dwordx4 v[68:71], v1, s[24:27], s52 offen offset:3072 sc1
    s_add_u32 s52, s31, s59
    s_add_u32 s59, s59, 4096
    s_and_b32 s59, s59, 0x3fff
    buffer_load_dwordx4 v[72:75], v1, s[24:27], s52 offen offset:0 sc1
    buffer_load_dwordx4 v[76:79], v1, s[24:27], s52 offen offset:1024 sc1
    s_branch L_pg86
.p2align 12
L_pg86:
    s_waitcnt vmcnt(10)
    s_mov_b64 exec, 1
    s_cbranch_vccz L_slow87
    buffer_store_dword v20, v2, s[24:27], s30 offen
L_join88:
    s_mov_b64 exec, -1
    s_waitcnt lgkmcnt(0)
    s_barrier
L_at_E_89:
    ds_read_b64_tr_b16 v[80:81], v4 offset:0
    ds_read_b64_tr_b16 v[82:83], v4 offset:1024
    ds_read_b64_tr_b16 v[84:85], v5 offset:0
    ds_read_b64_tr_b16 v[86:87], v5 offset:1024
    ds_read_b64_tr_b16 v[88:89], v6 offset:0
    ds_read_b64_tr_b16 v[90:91], v6 offset:1024
    ds_read_b64_tr_b16 v[92:93], v7 offset:0
    ds_read_b64_tr_b16 v[94:95], v7 offset:1024
    ds_read_b64_tr_b16 v[96:97], v4 offset:4096
    ds_read_b64_tr_b16 v[98:99], v4 offset:5120
    ds_read_b64_tr_b16 v[100:101], v5 offset:4096
    ds_read_b64_tr_b16 v[102:103], v5 offset:5120
    ds_read_b64_tr_b16 v[104:105], v6 offset:4096
    ds_read_b64_tr_b16 v[106:107], v6 offset:5120
    ds_read_b64_tr_b16 v[108:109], v7 offset:4096
    ds_read_b64_tr_b16 v[110:111], v7 offset:5120
    ds_read_b64_tr_b16 v[112:113], v4 offset:8192
    ds_read_b64_tr_b16 v[114:115], v4 offset:9216
    ds_read_b64_tr_b16 v[116:117], v5 offset:8192
    ds_read_b64_tr_b16 v[118:119], v5 offset:9216
    ds_read_b64_tr_b16 v[120:121], v6 offset:8192
    ds_read_b64_tr_b16 v[122:123], v6 offset:9216
    ds_read_b64_tr_b16 v[124:125], v7 offset:8192
    ds_read_b64_tr_b16 v[126:127], v7 offset:9216
    s_waitcnt vmcnt(10) lgkmcnt(15)
    v_mfma_f32_16x16x32_bf16 v[24:27], v[80:83], v[40:43], v[24:27]
    ds_read_b64_tr_b16 v[128:129], v4 offset:12288
    ds_read_b64_tr_b16 v[130:131], v4 offset:13312
    v_mfma_f32_16x16x32_bf16 v[28:31], v[84:87], v[40:43], v[28:31]
    ds_read_b64_tr_b16 v[132:133], v5 offset:12288
    ds_read_b64_tr_b16 v[134:135], v5 offset:13312
    v_mfma_f32_16x16x32_bf16 v[32:35], v[88:91], v[40:43], v[32:35]
    ds_read_b64_tr_b16 v[136:137], v6 offset:12288
    ds_read_b64_tr_b16 v[138:139], v6 offset:13312
    v_mfma_f32_16x16x32_bf16 v[36:39], v[92:95], v[40:43], v[36:39]
    ds_read_b64_tr_b16 v[140:141], v7 offset:12288
    ds_read_b64_tr_b16 v[142:143], v7 offset:13312
    s_waitcnt vmcnt(9) lgkmcnt(15)
    v_mfma_f32_16x16x32_bf16 v[24:27], v[96:99], v[44:47], v[24:27]
    buffer_load_dwordx4 v[40:43], v1, s[24:27], s52 offen offset:2048 sc1
    ds_read_b64_tr_b16 v[144:145], v4 offset:16384
    ds_read_b64_tr_b16 v[146:147], v4 offset:17408
    v_mfma_f32_16x16x32_bf16 v[28:31], v[100:103], v[44:47], v[28:31]
    ds_read_b64_tr_b16 v[148:149], v5 offset:16384
    ds_read_b64_tr_b16 v[150:151], v5 offset:17408
    v_mfma_f32_16x16x32_bf16 v[32:35], v[104:107], v[44:47], v[32:35]
    ds_read_b64_tr_b16 v[152:153], v6 offset:16384
    ds_read_b64_tr_b16 v[154:155], v6 offset:17408
    v_mfma_f32_16x16x32_bf16 v[36:39], v[108:111], v[44:47], v[36:39]
    ds_read_b64_tr_b16 v[156:157], v7 offset:16384
    ds_read_b64_tr_b16 v[158:159], v7 offset:17408
    s_waitcnt vmcnt(9) lgkmcnt(15)
    v_mfma_f32_16x16x32_bf16 v[24:27], v[112:115], v[48:51], v[24:27]
    buffer_load_dwordx4 v[44:47], v1, s[24:27], s52 offen offset:3072 sc1
    ds_read_b64_tr_b16 v[160:161], v4 offset:20480
    ds_read_b64_tr_b16 v[162:163], v4 offset:21504
    v_mfma_f32_16x16x32_bf16 v[28:31], v[116:119], v[48:51], v[28:31]
    ds_read_b64_tr_b16 v[164:165], v5 offset:20480
    ds_read_b64_tr_b16 v[166:167], v5 offset:21504
    v_mfma_f32_16x16x32_bf16 v[32:35], v[120:123], v[48:51], v[32:35]
    ds_read_b64_tr_b16 v[168:169], v6 offset:20480
    ds_read_b64_tr_b16 v[170:171], v6 offset:21504
    v_mfma_f32_16x16x32_bf16 v[36:39], v[124:127], v[48:51], v[36:39]
    ds_read_b64_tr_b16 v[172:173], v7 offset:20480
    ds_read_b64_tr_b16 v[174:175], v7 offset:21504
    s_waitcnt vmcnt(9) lgkmcnt(15)
    v_mfma_f32_16x16x32_bf16 v[24:27], v[128:131], v[52:55], v[24:27]
    s_add_u32 s52, s31, s59
    s_add_u32 s59, s59, 4096
    s_and_b32 s59, s59, 0x3fff
    buffer_load_dwordx4 v[48:51], v1, s[24:27], s52 offen offset:0 sc1
    ds_read_b64_tr_b16 v[176:177], v4 offset:24576
    ds_read_b64_tr_b16 v[178:179], v4 offset:25600
    v_mfma_f32_16x16x32_bf16 v[28:31], v[132:135], v[52:55], v[28:31]
    ds_read_b64_tr_b16 v[180:181], v5 offset:24576
    ds_read_b64_tr_b16 v[182:183], v5 offset:25600
    v_mfma_f32_16x16x32_bf16 v[32:35], v[136:139], v[52:55], v[32:35]
    ds_read_b64_tr_b16 v[184:185], v6 offset:24576
    ds_read_b64_tr_b16 v[186:187], v6 offset:25600
    v_mfma_f32_16x16x32_bf16 v[36:39], v[140:143], v[52:55], v[36:39]
    ds_read_b64_tr_b16 v[188:189], v7 offset:24576
    ds_read_b64_tr_b16 v[190:191], v7 offset:25600
    s_waitcnt vmcnt(9) lgkmcnt(15)
    v_mfma_f32_16x16x32_bf16 v[24:27], v[144:147], v[56:59], v[24:27]
    buffer_load_dwordx4 v[52:55], v1, s[24:27], s52 offen offset:1024 sc1
    ds_read_b64_tr_b16 v[192:193], v4 offset:28672
    ds_read_b64_tr_b16 v[194:195], v4 offset:29696
    v_mfma_f32_16x16x32_bf16 v[28:31], v[148:151], v[56:59], v[28:31]
    ds_read_b64_tr_b16 v[196:197], v5 offset:28672
    ds_read_b64_tr_b16 v[198:199], v5 offset:29696
    v_mfma_f32_16x16x32_bf16 v[32:35], v[152:155], v[56:59], v[32:35]
    ds_read_b64_tr_b16 v[200:201], v6 offset:28672
    ds_read_b64_tr_b16 v[202:203], v6 offset:29696
    v_mfma_f32_16x16x32_bf16 v[36:39], v[156:159], v[56:59], v[36:39]
    ds_read_b64_tr_b16 v[204:205], v7 offset:28672
    ds_read_b64_tr_b16 v[206:207], v7 offset:29696
    s_waitcnt vmcnt(9) lgkmcnt(15)
    v_mfma_f32_16x16x32_bf16 v[24:27], v[160:163], v[60:63], v[24:27]
    buffer_load_dwordx4 v[56:59], v1, s[24:27], s52 offen offset:2048 sc1
    ds_read_b64_tr_b16 v[208:209], v4 offset:32768
    ds_read_b64_tr_b16 v[210:211], v4 offset:33792
    v_mfma_f32_16x16x32_bf16 v[28:31], v[164:167], v[60:63], v[28:31]
    ds_read_b64_tr_b16 v[212:213], v5 offset:32768
    ds_read_b64_tr_b16 v[214:215], v5 offset:33792
    v_mfma_f32_16x16x32_bf16 v[32:35], v[168:171], v[60:63], v[32:35]
    ds_read_b64_tr_b16 v[216:217], v6 offset:32768
    ds_read_b64_tr_b16 v[218:219], v6 offset:33792
    v_mfma_f32_16x16x32_bf16 v[36:39], v[172:175], v[60:63], v[36:39]
    ds_read_b64_tr_b16 v[220:221], v7 offset:32768
    ds_read_b64_tr_b16 v[222:223], v7 offset:33792
    s_waitcnt vmcnt(9) lgkmcnt(15)
    v_mfma_f32_16x16x32_bf16 v[24:27], v[176:179], v[64:67], v[24:27]
    buffer_load_dwordx4 v[60:63], v1, s[24:27], s52 offen offset:3072 sc1
    ds_read_b64_tr_b16 v[224:225], v4 offset:36864
    ds_read_b64_tr_b16 v[226:227], v4 offset:37888
    v_mfma_f32_16x16x32_bf16 v[28:31], v[180:183], v[64:67], v[28:31]
    ds_read_b64_tr_b16 v[228:229], v5 offset:36864
    ds_read_b64_tr_b16 v[230:231], v5 offset:37888
    v_mfma_f32_16x16x32_bf16 v[32:35], v[184:187], v[64:67], v[32:35]
    ds_read_b64_tr_b16 v[232:233], v6 offset:36864
    ds_read_b64_tr_b16 v[234:235], v6 offset:37888
    v_mfma_f32_16x16x32_bf16 v[36:39], v[188:191], v[64:67], v[36:39]
    ds_read_b64_tr_b16 v[236:237], v7 offset:36864
    ds_read_b64_tr_b16 v[238:239], v7 offset:37888
    s_waitcnt vmcnt(9) lgkmcnt(15)
    v_mfma_f32_16x16x32_bf16 v[24:27], v[192:195], v[68:71], v[24:27]
    ds_read_b64_tr_b16 v[240:241], v4 offset:40960
    ds_read_b64_tr_b16 v[242:243], v4 offset:41984
    v_mfma_f32_16x16x32_bf16 v[28:31], v[196:199], v[68:71], v[28:31]
    ds_read_b64_tr_b16 v[244:245], v5 offset:40960
    ds_read_b64_tr_b16 v[246:247], v5 offset:41984
    v_mfma_f32_16x16x32_bf16 v[32:35], v[200:203], v[68:71], v[32:35]
    ds_read_b64_tr_b16 v[248:249], v6 offset:40960
    ds_read_b64_tr_b16 v[250:251], v6 offset:41984
    v_mfma_f32_16x16x32_bf16 v[36:39], v[204:207], v[68:71], v[36:39]
    ds_read_b64_tr_b16 v[252:253], v7 offset:40960
    ds_read_b64_tr_b16 v[254:255], v7 offset:41984
    s_waitcnt vmcnt(8) lgkmcnt(15)
    v_mfma_f32_16x16x32_bf16 v[24:27], v[208:211], v[72:75], v[24:27]
    ds_read_b64_tr_b16 v[80:81], v4 offset:45056
    ds_read_b64_tr_b16 v[82:83], v4 offset:46080
    v_mfma_f32_16x16x32_bf16 v[28:31], v[212:215], v[72:75], v[28:31]
    ds_read_b64_tr_b16 v[84:85], v5 offset:45056
    ds_read_b64_tr_b16 v[86:87], v5 offset:46080
    v_mfma_f32_16x16x32_bf16 v[32:35], v[216:219], v[72:75], v[32:35]
    ds_read_b64_tr_b16 v[88:89], v6 offset:45056
    ds_read_b64_tr_b16 v[90:91], v6 offset:46080
    v_mfma_f32_16x16x32_bf16 v[36:39], v[220:223], v[72:75], v[36:39]
    ds_read_b64_tr_b16 v[92:93], v7 offset:45056
    ds_read_b64_tr_b16 v[94:95], v7 offset:46080
    s_waitcnt vmcnt(7) lgkmcnt(15)
    v_mfma_f32_16x16x32_bf16 v[24:27], v[224:227], v[76:79], v[24:27]
    ds_read_b64_tr_b16 v[96:97], v4 offset:49152
    ds_read_b64_tr_b16 v[98:99], v4 offset:50176
    v_mfma_f32_16x16x32_bf16 v[28:31], v[228:231], v[76:79], v[28:31]
    ds_read_b64_tr_b16 v[100:101], v5 offset:49152
    ds_read_b64_tr_b16 v[102:103], v5 offset:50176
    v_mfma_f32_16x16x32_bf16 v[32:35], v[232:235], v[76:79], v[32:35]
    ds_read_b64_tr_b16 v[104:105], v6 offset:49152
    ds_read_b64_tr_b16 v[106:107], v6 offset:50176
    v_mfma_f32_16x16x32_bf16 v[36:39], v[236:239], v[76:79], v[36:39]
    ds_read_b64_tr_b16 v[108:109], v7 offset:49152
    ds_read_b64_tr_b16 v[110:111], v7 offset:50176
    s_waitcnt vmcnt(5) lgkmcnt(15)
    v_mfma_f32_16x16x32_bf16 v[24:27], v[240:243], v[40:43], v[24:27]
    ds_read_b64_tr_b16 v[112:113], v4 offset:53248
    ds_read_b64_tr_b16 v[114:115], v4 offset:54272
    v_mfma_f32_16x16x32_bf16 v[28:31], v[244:247], v[40:43], v[28:31]
    ds_read_b64_tr_b16 v[116:117], v5 offset:53248
    ds_read_b64_tr_b16 v[118:119], v5 offset:54272
    v_mfma_f32_16x16x32_bf16 v[32:35], v[248:251], v[40:43], v[32:35]
    ds_read_b64_tr_b16 v[120:121], v6 offset:53248
    ds_read_b64_tr_b16 v[122:123], v6 offset:54272
    v_mfma_f32_16x16x32_bf16 v[36:39], v[252:255], v[40:43], v[36:39]
    ds_read_b64_tr_b16 v[124:125], v7 offset:53248
    ds_read_b64_tr_b16 v[126:127], v7 offset:54272
    s_waitcnt vmcnt(4) lgkmcnt(15)
    v_mfma_f32_16x16x32_bf16 v[24:27], v[80:83], v[44:47], v[24:27]
    ds_read_b64_tr_b16 v[128:129], v4 offset:57344
    ds_read_b64_tr_b16 v[130:131], v4 offset:58368
    v_mfma_f32_16x16x32_bf16 v[28:31], v[84:87], v[44:47], v[28:31]
    ds_read_b64_tr_b16 v[132:133], v5 offset:57344
    ds_read_b64_tr_b16 v[134:135], v5 offset:58368
    v_mfma_f32_16x16x32_bf16 v[32:35], v[88:91], v[44:47], v[32:35]
    ds_read_b64_tr_b16 v[136:137], v6 offset:57344
    ds_read_b64_tr_b16 v[138:139], v6 offset:58368
    v_mfma_f32_16x16x32_bf16 v[36:39], v[92:95], v[44:47], v[36:39]
    ds_read_b64_tr_b16 v[140:141], v7 offset:57344
    ds_read_b64_tr_b16 v[142:143], v7 offset:58368
    s_waitcnt vmcnt(3) lgkmcnt(15)
    v_mfma_f32_16x16x32_bf16 v[24:27], v[96:99], v[48:51], v[24:27]
    ds_read_b64_tr_b16 v[144:145], v4 offset:61440
    ds_read_b64_tr_b16 v[146:147], v4 offset:62464
    v_mfma_f32_16x16x32_bf16 v[28:31], v[100:103], v[48:51], v[28:31]
    ds_read_b64_tr_b16 v[148:149], v5 offset:61440
    ds_read_b64_tr_b16 v[150:151], v5 offset:62464
    v_mfma_f32_16x16x32_bf16 v[32:35], v[104:107], v[48:51], v[32:35]
    ds_read_b64_tr_b16 v[152:153], v6 offset:61440
    ds_read_b64_tr_b16 v[154:155], v6 offset:62464
    v_mfma_f32_16x16x32_bf16 v[36:39], v[108:111], v[48:51], v[36:39]
    ds_read_b64_tr_b16 v[156:157], v7 offset:61440
    ds_read_b64_tr_b16 v[158:159], v7 offset:62464
    s_waitcnt vmcnt(2) lgkmcnt(15)
    v_mfma_f32_16x16x32_bf16 v[24:27], v[112:115], v[52:55], v[24:27]
    v_mfma_f32_16x16x32_bf16 v[28:31], v[116:119], v[52:55], v[28:31]
    v_mfma_f32_16x16x32_bf16 v[32:35], v[120:123], v[52:55], v[32:35]
    v_mfma_f32_16x16x32_bf16 v[36:39], v[124:127], v[52:55], v[36:39]
    s_waitcnt vmcnt(1) lgkmcnt(8)
    v_mfma_f32_16x16x32_bf16 v[24:27], v[128:131], v[56:59], v[24:27]
    v_mfma_f32_16x16x32_bf16 v[28:31], v[132:135], v[56:59], v[28:31]
    v_mfma_f32_16x16x32_bf16 v[32:35], v[136:139], v[56:59], v[32:35]
    v_mfma_f32_16x16x32_bf16 v[36:39], v[140:143], v[56:59], v[36:39]
    s_waitcnt vmcnt(0) lgkmcnt(0)
    v_mfma_f32_16x16x32_bf16 v[24:27], v[144:147], v[60:63], v[24:27]
    v_mfma_f32_16x16x32_bf16 v[28:31], v[148:151], v[60:63], v[28:31]
    v_mfma_f32_16x16x32_bf16 v[32:35], v[152:155], v[60:63], v[32:35]
    v_mfma_f32_16x16x32_bf16 v[36:39], v[156:159], v[60:63], v[36:39]
L_s3join:
L_at_s3mf_94:
    s_nop 4
    v_cvt_pk_bf16_f32 v40, v24, v25
    v_cvt_pk_bf16_f32 v41, v26, v27
    v_cvt_pk_bf16_f32 v42, v28, v29
    v_cvt_pk_bf16_f32 v43, v30, v31
    buffer_store_dwordx4 v[40:43], v1, s[24:27], s34 offen offset:0 sc1
    v_cvt_pk_bf16_f32 v44, v32, v33
    v_cvt_pk_bf16_f32 v45, v34, v35
    v_cvt_pk_bf16_f32 v46, v36, v37
    v_cvt_pk_bf16_f32 v47, v38, v39
    buffer_store_dwordx4 v[44:47], v1, s[24:27], s34 offen offset:1024 sc1
    v_pk_add_f32 v[48:49], v[24:25], v[26:27]
    v_pk_mul_f32 v[50:51], v[24:25], v[24:25]
    v_pk_fma_f32 v[50:51], v[26:27], v[26:27], v[50:51]
    v_pk_add_f32 v[48:49], v[48:49], v[28:29]
    v_pk_fma_f32 v[50:51], v[28:29], v[28:29], v[50:51]
    v_pk_add_f32 v[48:49], v[48:49], v[30:31]
    v_pk_fma_f32 v[50:51], v[30:31], v[30:31], v[50:51]
    v_pk_add_f32 v[48:49], v[48:49], v[32:33]
    v_pk_fma_f32 v[50:51], v[32:33], v[32:33], v[50:51]
    v_pk_add_f32 v[48:49], v[48:49], v[34:35]
    v_pk_fma_f32 v[50:51], v[34:35], v[34:35], v[50:51]
    v_pk_add_f32 v[48:49], v[48:49], v[36:37]
    v_pk_fma_f32 v[50:51], v[36:37], v[36:37], v[50:51]
    v_pk_add_f32 v[48:49], v[48:49], v[38:39]
    v_pk_fma_f32 v[50:51], v[38:39], v[38:39], v[50:51]
    v_add_f32 v48, v48, v49
    v_add_f32 v50, v50, v51
    s_nop 1
    v_permlane16_swap_b32 v48, v50
    v_add_f32 v48, v48, v50
    v_mov_b32 v50, v48
    s_nop 1
    v_permlane32_swap_b32 v48, v50
    v_add_f32 v48, v48, v50
    s_mov_b32 exec_hi, 0
    buffer_store_dword v48, v3, s[24:27], s36 offen sc1
    s_mov_b32 exec_hi, -1
L_at_s3end_95:
    s_xor_b32 s52, s46, 2
    s_lshl_b32 s59, s52, 14
    s_lshl_b32 s53, s52, 8
    s_add_u32 s53, s53, 160768
    v_add_u32 v13, s53, v1
    s_lshl_b32 s53, s52, 9
    s_add_u32 s53, s53, 161792
    v_lshl_add_u32 v14, v0, 3, s53
    s_lshl2_add_u32 s52, s46, s48
    v_add_u32 v8, s52, v1
    s_lshl4_add_u32 s52, s45, s48
    v_and_b32 v15, 12, v3
    s_mov_b32 exec_lo, 0xffffff00
    v_add_u32 v8, s52, v15
    s_mov_b64 exec, -1
    v_add_u32 v8, 479616, v8
    s_lshl_b32 s58, s51, 10
    s_waitcnt vmcnt(0)
    s_mov_b64 exec, 1
    s_cbranch_vccz L_slow96
    buffer_store_dword v20, v2, s[24:27], s30 offen offset:256
L_join97:
    s_mov_b64 exec, -1
L_at_flagC_98:
    buffer_load_dword v22, v8, s[24:27], 0 offen sc1
    s_mov_b32 s68, 0
    s_waitcnt vmcnt(0)
L_poll99:
    v_cmp_ne_u32 s[60:61], s49, v22
    s_nop 0
    s_and_b64 s[60:61], s[60:61], s[38:39]
    s_cbranch_scc0 L_pdone100
    buffer_load_dword v22, v8, s[24:27], 0 offen sc1
    s_add_u32 s68, s68, 1
    s_cmp_lt_u32 s68, 200000
    s_waitcnt vmcnt(0)
    s_cbranch_scc1 L_poll99
L_pdone100:
L_at_pollC_101:
    buffer_load_dword v24, v3, s[24:27], s35 offen offset:0 sc1
    buffer_load_dword v25, v3, s[24:27], s35 offen offset:256 sc1
    buffer_load_dword v26, v3, s[24:27], s35 offen offset:512 sc1
    buffer_load_dword v27, v3, s[24:27], s35 offen offset:768 sc1
    s_add_u32 m0, s59, 61440
    s_add_u32 s52, s37, s58
    buffer_load_dwordx4 v1, s[24:27], s52 offen sc1 lds
    buffer_load_dwordx4 v1, s[24:27], s52 offen offset:1024 sc1 lds
    buffer_load_dwordx4 v1, s[24:27], s52 offen offset:2048 sc1 lds
    buffer_load_dwordx4 v1, s[24:27], s52 offen offset:3072 sc1 lds
    s_add_u32 s58, s58, 4096
    s_and_b32 s58, s58, 0x3fff
    s_add_u32 m0, s59, 65536
    s_add_u32 s52, s37, s58
    buffer_load_dwordx4 v1, s[24:27], s52 offen sc1 lds
    buffer_load_dwordx4 v1, s[24:27], s52 offen offset:1024 sc1 lds
    buffer_load_dwordx4 v1, s[24:27], s52 offen offset:2048 sc1 lds
    buffer_load_dwordx4 v1, s[24:27], s52 offen offset:3072 sc1 lds
    s_add_u32 s58, s58, 4096
    s_and_b32 s58, s58, 0x3fff
    s_add_u32 m0, s59, 69632
    s_add_u32 s52, s37, s58
    buffer_load_dwordx4 v1, s[24:27], s52 offen sc1 lds
    buffer_load_dwordx4 v1, s[24:27], s52 offen offset:1024 sc1 lds
    buffer_load_dwordx4 v1, s[24:27], s52 offen offset:2048 sc1 lds
    buffer_load_dwordx4 v1, s[24:27], s52 offen offset:3072 sc1 lds
    s_add_u32 s58, s58, 4096
    s_and_b32 s58, s58, 0x3fff
    s_add_u32 m0, s59, 73728
    s_add_u32 s52, s37, s58
    buffer_load_dwordx4 v1, s[24:27], s52 offen sc1 lds
    buffer_load_dwordx4 v1, s[24:27], s52 offen offset:1024 sc1 lds
    buffer_load_dwordx4 v1, s[24:27], s52 offen offset:2048 sc1 lds
    buffer_load_dwordx4 v1, s[24:27], s52 offen offset:3072 sc1 lds
    s_add_u32 s58, s58, 4096
    s_and_b32 s58, s58, 0x3fff
    s_waitcnt vmcnt(16)
    v_add_f32 v24, v24, v25
    v_add_f32 v26, v26, v27
    v_add_f32 v24, v24, v26
    v_mov_b32 v25, v24
    s_nop 1
    v_permlane32_swap_b32 v24, v25
    v_add_f32 v24, v24, v25
    v_mov_b32 v25, v24
    s_nop 1
    v_permlane16_swap_b32 v24, v25
    v_mul_f32 v24, 0xbb000000, v24
    v_mul_f32 v25, 0x3b000000, v25
    v_fma_f32 v25, -v24, v24, v25
    v_max_f32 v25, 0, v25
    v_add_f32 v26, 0x3727c5ac, v25
    v_rsq_f32 v26, v26
    s_mov_b64 s[60:61], 0xffff
    v_mul_f32 v25, v25, v26
    v_fmaak_f32 v25, v25, v26, 0x3727c5ac
    v_rsq_f32 v25, v25
    v_mov_b32 v31, 1
    v_mul_f32 v25, v25, v26
    v_rcp_f32 v30, v25
    v_mul_f32 v28, 0xc0135761, v25
    v_mul_f32 v29, v25, v25
    v_mul_f32 v29, v29, v25
    v_mul_f32 v29, 0xbdd2d3e8, v29
    v_cndmask_b32 v24, v24, v30, s[60:61]
    v_cvt_pk_bf16_f32 v25, v24, 0
    v_lshlrev_b32 v25, 16, v25
    v_sub_f32 v25, v24, v25
    v_cndmask_b32 v26, v24, v25, s[60:61]
    v_cvt_pk_bf16_f32 v26, v24, v26
    v_cvt_pk_bf16_f32 v27, v25, 0
    ds_write_b64 v14, v[26:27]
    s_mov_b64 exec, 0xffff
    s_waitcnt vmcnt(0)
    ds_write_b128 v13, v[28:31]
    s_mov_b64 exec, -1
L_at_hrdy_102:
    s_setprio 0
    s_branch L_pg103
L_fallback1:
    s_mov_b32 s59, 1
    v_mov_b32 v88, v188
    v_mov_b32 v89, v189
    v_mov_b32 v90, v190
    v_mov_b32 v91, v191
    s_branch L_fb_go
L_fallback0:
    s_mov_b32 s59, 0
    v_mov_b32 v88, v184
    v_mov_b32 v89, v185
    v_mov_b32 v90, v186
    v_mov_b32 v91, v187
L_fb_go:
    v_and_b32 v206, 15, v0
    v_lshrrev_b32 v207, 5, v0
    v_lshl_add_u32 v206, v207, 4, v206
    v_lshlrev_b32 v206, 4, v206
    v_mov_b32 v204, 0xff61b1e6
    v_mov_b32 v120, 0
    v_mov_b32 v121, 0
    v_mov_b32 v122, 0
    v_mov_b32 v123, 0
    v_mov_b32 v124, 0
    v_mov_b32 v125, 0
    v_mov_b32 v126, 0
    v_mov_b32 v127, 0
    v_mov_b32 v128, 0
    v_mov_b32 v129, 0
    v_mov_b32 v130, 0
    v_mov_b32 v131, 0
    v_mov_b32 v132, 0
    v_mov_b32 v133, 0
    v_mov_b32 v134, 0
    v_mov_b32 v135, 0
    v_mov_b32 v196, 0x3f803f80
    v_mov_b32 v197, 0x3f803f80
    v_mov_b32 v198, 0x3f803f80
    v_mov_b32 v199, 0x3f803f80
    v_mov_b32 v200, 0x3f803f80
    v_mov_b32 v201, 0x3f803f80
    v_mov_b32 v202, 0x3f803f80
    v_mov_b32 v203, 0x3f803f80
    s_lshl1_add_u32 s58, s44, s59
    s_min_u32 s62, s58, 8
L_fb_k0:
    s_sub_u32 s54, s58, s62
    s_and_b32 s68, s54, 1
    s_lshl_b32 s68, s68, 11
    s_lshr_b32 s54, s54, 1
    s_sub_u32 s54, s44, s54
    s_lshl_b32 s54, s54, 19
    s_sub_u32 s54, s4, s54
    s_add_u32 s54, s54, s68
    buffer_load_dwordx4 v[192:195], v1, s[24:27], s54 offen sc1
    s_waitcnt vmcnt(0)
    s_cmp_eq_u32 s62, 8
    s_cbranch_scc1 L_fb_u0
    s_cmp_eq_u32 s62, 0
    s_cbranch_scc1 L_fb_l0
    v_mfma_f32_32x32x16_bf16 v[104:119], v[192:195], v[88:91], 0
    s_branch L_fb_s0
L_fb_u0:
    v_mfma_f32_32x32x16_bf16 v[104:119], v[192:195], v[88:91], v[160:175]
    s_branch L_fb_s0
L_fb_l0:
    v_mfma_f32_32x32x16_bf16 v[104:119], v[192:195], v[88:91], v[144:159]
L_fb_s0:
    s_nop 7
    s_nop 3
    v_max3_f32 v204, v204, v104, v105
    v_max3_f32 v204, v204, v106, v107
    v_max3_f32 v204, v204, v108, v109
    v_max3_f32 v204, v204, v110, v111
    v_max3_f32 v204, v204, v112, v113
    v_max3_f32 v204, v204, v114, v115
    v_max3_f32 v204, v204, v116, v117
    v_max3_f32 v204, v204, v118, v119
    s_sub_u32 s62, s62, 1
    s_cbranch_scc0 L_fb_k0
    v_mov_b32 v205, v204
    s_nop 1
    v_permlane32_swap_b32 v204, v205
    v_max_f32 v204, v204, v205
    s_lshl1_add_u32 s58, s44, s59
    s_min_u32 s62, s58, 8
L_fb_k1:
    s_sub_u32 s54, s58, s62
    s_and_b32 s68, s54, 1
    s_lshl_b32 s68, s68, 11
    s_lshr_b32 s54, s54, 1
    s_sub_u32 s54, s44, s54
    s_lshl_b32 s54, s54, 19
    s_sub_u32 s54, s4, s54
    s_add_u32 s54, s54, s68
    buffer_load_dwordx4 v[192:195], v1, s[24:27], s54 offen sc1
    s_mov_b32 exec_lo, 0xffff
    s_mov_b32 exec_hi, 0xffff
    buffer_load_dwordx4 v[196:199], v206, s[24:27], s54 offen offset:1024 sc1
    buffer_load_dwordx4 v[200:203], v206, s[24:27], s54 offen offset:1536 sc1
    s_mov_b64 exec, -1
    s_waitcnt vmcnt(0)
    s_cmp_eq_u32 s62, 8
    s_cbranch_scc1 L_fb_u1
    s_cmp_eq_u32 s62, 0
    s_cbranch_scc1 L_fb_l1
    v_mfma_f32_32x32x16_bf16 v[104:119], v[192:195], v[88:91], 0
    s_branch L_fb_s1
L_fb_u1:
    v_mfma_f32_32x32x16_bf16 v[104:119], v[192:195], v[88:91], v[160:175]
    s_branch L_fb_s1
L_fb_l1:
    v_mfma_f32_32x32x16_bf16 v[104:119], v[192:195], v[88:91], v[144:159]
L_fb_s1:
    s_nop 7
    s_nop 3
    v_sub_f32 v104, v104, v204
    v_sub_f32 v105, v105, v204
    v_sub_f32 v106, v106, v204
    v_sub_f32 v107, v107, v204
    v_sub_f32 v108, v108, v204
    v_sub_f32 v109, v109, v204
    v_sub_f32 v110, v110, v204
    v_sub_f32 v111, v111, v204
    v_sub_f32 v112, v112, v204
    v_sub_f32 v113, v113, v204
    v_sub_f32 v114, v114, v204
    v_sub_f32 v115, v115, v204
    v_sub_f32 v116, v116, v204
    v_sub_f32 v117, v117, v204
    v_sub_f32 v118, v118, v204
    v_sub_f32 v119, v119, v204
    v_exp_f32 v104, v104
    v_exp_f32 v105, v105
    v_exp_f32 v106, v106
    v_exp_f32 v107, v107
    v_exp_f32 v108, v108
    v_exp_f32 v109, v109
    v_exp_f32 v110, v110
    v_exp_f32 v111, v111
    v_exp_f32 v112, v112
    v_exp_f32 v113, v113
    v_exp_f32 v114, v114
    v_exp_f32 v115, v115
    v_exp_f32 v116, v116
    v_exp_f32 v117, v117
    v_exp_f32 v118, v118
    v_exp_f32 v119, v119
    v_cvt_pk_bf16_f32 v136, v104, v105
    v_cvt_pk_bf16_f32 v137, v106, v107
    v_cvt_pk_bf16_f32 v138, v108, v109
    v_cvt_pk_bf16_f32 v139, v110, v111
    v_cvt_pk_bf16_f32 v140, v112, v113
    v_cvt_pk_bf16_f32 v141, v114, v115
    v_cvt_pk_bf16_f32 v142, v116, v117
    v_cvt_pk_bf16_f32 v143, v118, v119
    v_mfma_f32_32x32x16_bf16 v[120:135], v[196:199], v[136:139], v[120:135]
    s_nop 0
    v_mfma_f32_32x32x16_bf16 v[120:135], v[200:203], v[140:143], v[120:135]
    s_nop 7
    s_nop 3
    s_sub_u32 s62, s62, 1
    s_cbranch_scc0 L_fb_k1
    s_cmp_eq_u32 s59, 0
    s_cbranch_scc1 L_fb_r0
L_fb_r1:
    v_mov_b32 v72, v120
    v_mov_b32 v73, v121
    v_mov_b32 v74, v122
    v_mov_b32 v75, v123
    v_mov_b32 v76, v124
    v_mov_b32 v77, v125
    v_mov_b32 v78, v126
    v_mov_b32 v79, v127
    v_mov_b32 v80, v128
    s_branch L_fb_done1
L_fb_r0:
    v_mov_b32 v56, v120
    v_mov_b32 v57, v121
    v_mov_b32 v58, v122
    v_mov_b32 v59, v123
    v_mov_b32 v60, v124
    v_mov_b32 v61, v125
    v_mov_b32 v62, v126
    v_mov_b32 v63, v127
    v_mov_b32 v64, v128
    s_branch L_fb_done0
.p2align 12
L_pg103:
    v_mov_b32 v15, 160272
L_sf104:
    ds_read_b32 v16, v15
    s_waitcnt lgkmcnt(0)
    v_readfirstlane_b32 s54, v16
    s_nop 0
    s_cmp_lt_u32 s54, 56
    s_cbranch_scc1 L_sf104
    s_add_u32 m0, s69, 0
    s_mov_b32 s54, 0
    buffer_load_dwordx4 v9, s[20:23], s54 offen lds
    s_add_u32 m0, s69, 1024
    s_mov_b32 s54, 4096
    buffer_load_dwordx4 v9, s[20:23], s54 offen lds
    s_add_u32 m0, s69, 2048
    s_mov_b32 s54, 8192
    buffer_load_dwordx4 v9, s[20:23], s54 offen lds
    s_add_u32 m0, s69, 3072
    s_mov_b32 s54, 12288
    buffer_load_dwordx4 v9, s[20:23], s54 offen lds
    s_add_u32 m0, s69, 4096
    s_mov_b32 s54, 32768
    buffer_load_dwordx4 v10, s[20:23], s54 offen lds
    s_add_u32 m0, s69, 5120
    s_mov_b32 s54, 40960
    buffer_load_dwordx4 v10, s[20:23], s54 offen lds
    s_add_u32 m0, s69, 6144
    s_mov_b32 s54, 49152
    buffer_load_dwordx4 v9, s[20:23], s54 offen lds
    s_add_u32 m0, s69, 7168
    s_mov_b32 s54, 53248
    buffer_load_dwordx4 v9, s[20:23], s54 offen lds
    s_add_u32 m0, s69, 8192
    s_mov_b32 s54, 57344
    s_waitcnt vmcnt(7)
    buffer_load_dwordx4 v9, s[20:23], s54 offen lds
    s_add_u32 m0, s69, 9216
    s_mov_b32 s54, 61440
    s_waitcnt vmcnt(7)
    buffer_load_dwordx4 v9, s[20:23], s54 offen lds
    s_add_u32 m0, s69, 10240
    s_mov_b32 s54, 81920
    s_waitcnt vmcnt(7)
    buffer_load_dwordx4 v10, s[20:23], s54 offen lds
    s_add_u32 m0, s69, 11264
    s_mov_b32 s54, 90112
    s_waitcnt vmcnt(7)
    buffer_load_dwordx4 v10, s[20:23], s54 offen lds
    ds_read_b64_tr_b16 v[80:81], v11 offset:0
    ds_read_b64_tr_b16 v[82:83], v11 offset:512
    ds_read_b64_tr_b16 v[84:85], v12 offset:0
    ds_read_b64_tr_b16 v[86:87], v12 offset:512
    s_add_u32 m0, s69, 12288
    s_mov_b32 s54, 98304
    s_waitcnt vmcnt(7)
    buffer_load_dwordx4 v9, s[20:23], s54 offen lds
    s_add_u32 m0, s69, 13312
    s_mov_b32 s54, 102400
    s_waitcnt vmcnt(7)
    buffer_load_dwordx4 v9, s[20:23], s54 offen lds
    ds_read_b64_tr_b16 v[88:89], v11 offset:2048
    ds_read_b64_tr_b16 v[90:91], v11 offset:2560
    ds_read_b64_tr_b16 v[92:93], v12 offset:2048
    ds_read_b64_tr_b16 v[94:95], v12 offset:2560
    s_waitcnt lgkmcnt(4)
    s_add_u32 m0, s69, 0
    s_mov_b32 s54, 106496
    s_waitcnt vmcnt(7)
    buffer_load_dwordx4 v9, s[20:23], s54 offen lds
    s_add_u32 m0, s69, 1024
    s_mov_b32 s54, 110592
    s_waitcnt vmcnt(7)
    buffer_load_dwordx4 v9, s[20:23], s54 offen lds
    ds_read_b64_tr_b16 v[96:97], v11 offset:4096
    ds_read_b64_tr_b16 v[98:99], v11 offset:4608
    ds_read_b64_tr_b16 v[100:101], v12 offset:4096
    ds_read_b64_tr_b16 v[102:103], v12 offset:4608
    s_waitcnt lgkmcnt(4)
    s_add_u32 m0, s69, 2048
    s_mov_b32 s54, 131072
    s_waitcnt vmcnt(7)
    buffer_load_dwordx4 v10, s[20:23], s54 offen lds
    s_add_u32 m0, s69, 3072
    s_mov_b32 s54, 139264
    s_waitcnt vmcnt(7)
    buffer_load_dwordx4 v10, s[20:23], s54 offen lds
    ds_read_b64_tr_b16 v[104:105], v11 offset:6144
    ds_read_b64_tr_b16 v[106:107], v11 offset:6656
    ds_read_b64_tr_b16 v[108:109], v12 offset:6144
    ds_read_b64_tr_b16 v[110:111], v12 offset:6656
    s_waitcnt lgkmcnt(4)
    s_add_u32 m0, s69, 4096
    s_mov_b32 s54, 147456
    s_waitcnt vmcnt(7)
    buffer_load_dwordx4 v9, s[20:23], s54 offen lds
    s_add_u32 m0, s69, 5120
    s_mov_b32 s54, 151552
    s_waitcnt vmcnt(7)
    buffer_load_dwordx4 v9, s[20:23], s54 offen lds
    ds_read_b64_tr_b16 v[112:113], v11 offset:8192
    ds_read_b64_tr_b16 v[114:115], v11 offset:8704
    ds_read_b64_tr_b16 v[116:117], v12 offset:8192
    ds_read_b64_tr_b16 v[118:119], v12 offset:8704
    s_waitcnt lgkmcnt(4)
    s_add_u32 m0, s69, 6144
    s_mov_b32 s54, 155648
    s_waitcnt vmcnt(7)
    buffer_load_dwordx4 v9, s[20:23], s54 offen lds
    s_add_u32 m0, s69, 7168
    s_mov_b32 s54, 159744
    s_waitcnt vmcnt(7)
    buffer_load_dwordx4 v9, s[20:23], s54 offen lds
    ds_read_b64_tr_b16 v[120:121], v11 offset:10240
    ds_read_b64_tr_b16 v[122:123], v11 offset:10752
    ds_read_b64_tr_b16 v[124:125], v12 offset:10240
    ds_read_b64_tr_b16 v[126:127], v12 offset:10752
    s_waitcnt lgkmcnt(4)
    s_add_u32 m0, s69, 8192
    s_mov_b32 s54, 180224
    s_waitcnt vmcnt(7)
    buffer_load_dwordx4 v9, s[20:23], s54 offen lds
    s_add_u32 m0, s69, 9216
    s_mov_b32 s54, 184320
    s_waitcnt vmcnt(7)
    buffer_load_dwordx4 v9, s[20:23], s54 offen lds
    ds_read_b64_tr_b16 v[128:129], v11 offset:12288
    ds_read_b64_tr_b16 v[130:131], v11 offset:12800
    ds_read_b64_tr_b16 v[132:133], v12 offset:12288
    ds_read_b64_tr_b16 v[134:135], v12 offset:12800
    s_waitcnt lgkmcnt(4)
    s_add_u32 m0, s69, 10240
    s_mov_b32 s54, 188416
    s_waitcnt vmcnt(7)
    buffer_load_dwordx4 v9, s[20:23], s54 offen lds
    s_add_u32 m0, s69, 11264
    s_mov_b32 s54, 192512
    s_waitcnt vmcnt(7)
    buffer_load_dwordx4 v9, s[20:23], s54 offen lds
    ds_read_b64_tr_b16 v[136:137], v11 offset:0
    ds_read_b64_tr_b16 v[138:139], v11 offset:512
    ds_read_b64_tr_b16 v[140:141], v12 offset:0
    ds_read_b64_tr_b16 v[142:143], v12 offset:512
    s_waitcnt lgkmcnt(4)
    s_add_u32 m0, s69, 12288
    s_mov_b32 s54, 212992
    s_waitcnt vmcnt(7)
    buffer_load_dwordx4 v10, s[20:23], s54 offen lds
    s_add_u32 m0, s69, 13312
    s_mov_b32 s54, 221184
    s_waitcnt vmcnt(7)
    buffer_load_dwordx4 v10, s[20:23], s54 offen lds
    ds_read_b64_tr_b16 v[144:145], v11 offset:2048
    ds_read_b64_tr_b16 v[146:147], v11 offset:2560
    ds_read_b64_tr_b16 v[148:149], v12 offset:2048
    ds_read_b64_tr_b16 v[150:151], v12 offset:2560
    s_waitcnt lgkmcnt(4)
    s_add_u32 m0, s69, 0
    s_mov_b32 s54, 229376
    s_waitcnt vmcnt(7)
    buffer_load_dwordx4 v9, s[20:23], s54 offen lds
    s_add_u32 m0, s69, 1024
    s_mov_b32 s54, 233472
    s_waitcnt vmcnt(7)
    buffer_load_dwordx4 v9, s[20:23], s54 offen lds
    ds_read_b64_tr_b16 v[152:153], v11 offset:4096
    ds_read_b64_tr_b16 v[154:155], v11 offset:4608
    ds_read_b64_tr_b16 v[156:157], v12 offset:4096
    ds_read_b64_tr_b16 v[158:159], v12 offset:4608
    s_waitcnt lgkmcnt(4)
    s_add_u32 m0, s69, 2048
    s_mov_b32 s54, 237568
    s_waitcnt vmcnt(7)
    buffer_load_dwordx4 v9, s[20:23], s54 offen lds
    s_add_u32 m0, s69, 3072
    s_mov_b32 s54, 241664
    s_waitcnt vmcnt(7)
    buffer_load_dwordx4 v9, s[20:23], s54 offen lds
    ds_read_b64_tr_b16 v[160:161], v11 offset:6144
    ds_read_b64_tr_b16 v[162:163], v11 offset:6656
    ds_read_b64_tr_b16 v[164:165], v12 offset:6144
    ds_read_b64_tr_b16 v[166:167], v12 offset:6656
    s_waitcnt lgkmcnt(4)
    s_add_u32 m0, s69, 4096
    s_mov_b32 s54, 262144
    s_waitcnt vmcnt(7)
    buffer_load_dwordx4 v10, s[20:23], s54 offen lds
    s_add_u32 m0, s69, 5120
    s_mov_b32 s54, 270336
    s_waitcnt vmcnt(7)
    buffer_load_dwordx4 v10, s[20:23], s54 offen lds
    ds_read_b64_tr_b16 v[168:169], v11 offset:8192
    ds_read_b64_tr_b16 v[170:171], v11 offset:8704
    ds_read_b64_tr_b16 v[172:173], v12 offset:8192
    ds_read_b64_tr_b16 v[174:175], v12 offset:8704
    s_waitcnt lgkmcnt(4)
    s_add_u32 m0, s69, 6144
    s_mov_b32 s54, 278528
    s_waitcnt vmcnt(7)
    buffer_load_dwordx4 v9, s[20:23], s54 offen lds
    s_add_u32 m0, s69, 7168
    s_mov_b32 s54, 282624
    s_waitcnt vmcnt(7)
    buffer_load_dwordx4 v9, s[20:23], s54 offen lds
    ds_read_b64_tr_b16 v[176:177], v11 offset:10240
    ds_read_b64_tr_b16 v[178:179], v11 offset:10752
    ds_read_b64_tr_b16 v[180:181], v12 offset:10240
    ds_read_b64_tr_b16 v[182:183], v12 offset:10752
    s_waitcnt lgkmcnt(4)
    s_add_u32 m0, s69, 8192
    s_mov_b32 s54, 286720
    s_waitcnt vmcnt(7)
    buffer_load_dwordx4 v9, s[20:23], s54 offen lds
    s_add_u32 m0, s69, 9216
    s_mov_b32 s54, 290816
    s_waitcnt vmcnt(7)
    buffer_load_dwordx4 v9, s[20:23], s54 offen lds
    ds_read_b64_tr_b16 v[184:185], v11 offset:12288
    ds_read_b64_tr_b16 v[186:187], v11 offset:12800
    ds_read_b64_tr_b16 v[188:189], v12 offset:12288
    ds_read_b64_tr_b16 v[190:191], v12 offset:12800
    s_waitcnt lgkmcnt(4)
    s_add_u32 m0, s69, 10240
    s_mov_b32 s54, 311296
    s_waitcnt vmcnt(7)
    buffer_load_dwordx4 v10, s[20:23], s54 offen lds
    s_add_u32 m0, s69, 11264
    s_mov_b32 s54, 319488
    s_waitcnt vmcnt(7)
    buffer_load_dwordx4 v10, s[20:23], s54 offen lds
    ds_read_b64_tr_b16 v[192:193], v11 offset:0
    ds_read_b64_tr_b16 v[194:195], v11 offset:512
    ds_read_b64_tr_b16 v[196:197], v12 offset:0
    ds_read_b64_tr_b16 v[198:199], v12 offset:512
    s_waitcnt lgkmcnt(4)
    s_add_u32 m0, s69, 12288
    s_mov_b32 s54, 327680
    s_waitcnt vmcnt(7)
    buffer_load_dwordx4 v9, s[20:23], s54 offen lds
    s_add_u32 m0, s69, 13312
    s_mov_b32 s54, 331776
    s_waitcnt vmcnt(7)
    buffer_load_dwordx4 v9, s[20:23], s54 offen lds
    ds_read_b64_tr_b16 v[200:201], v11 offset:2048
    ds_read_b64_tr_b16 v[202:203], v11 offset:2560
    ds_read_b64_tr_b16 v[204:205], v12 offset:2048
    ds_read_b64_tr_b16 v[206:207], v12 offset:2560
    s_waitcnt lgkmcnt(4)
    s_add_u32 m0, s69, 0
    s_mov_b32 s54, 335872
    s_waitcnt vmcnt(7)
    buffer_load_dwordx4 v9, s[20:23], s54 offen lds
    s_add_u32 m0, s69, 1024
    s_mov_b32 s54, 339968
    s_waitcnt vmcnt(7)
    buffer_load_dwordx4 v9, s[20:23], s54 offen lds
    ds_read_b64_tr_b16 v[208:209], v11 offset:4096
    ds_read_b64_tr_b16 v[210:211], v11 offset:4608
    ds_read_b64_tr_b16 v[212:213], v12 offset:4096
    ds_read_b64_tr_b16 v[214:215], v12 offset:4608
    ds_read_b64_tr_b16 v[216:217], v11 offset:6144
    ds_read_b64_tr_b16 v[218:219], v11 offset:6656
    ds_read_b64_tr_b16 v[220:221], v12 offset:6144
    ds_read_b64_tr_b16 v[222:223], v12 offset:6656
    s_waitcnt vmcnt(6)
    ds_read_b64_tr_b16 v[224:225], v11 offset:8192
    ds_read_b64_tr_b16 v[226:227], v11 offset:8704
    ds_read_b64_tr_b16 v[228:229], v12 offset:8192
    ds_read_b64_tr_b16 v[230:231], v12 offset:8704
    s_waitcnt vmcnt(4)
    ds_read_b64_tr_b16 v[232:233], v11 offset:10240
    ds_read_b64_tr_b16 v[234:235], v11 offset:10752
    ds_read_b64_tr_b16 v[236:237], v12 offset:10240
    ds_read_b64_tr_b16 v[238:239], v12 offset:10752
    s_waitcnt vmcnt(2)
    ds_read_b64_tr_b16 v[240:241], v11 offset:12288
    ds_read_b64_tr_b16 v[242:243], v11 offset:12800
    ds_read_b64_tr_b16 v[244:245], v12 offset:12288
    ds_read_b64_tr_b16 v[246:247], v12 offset:12800
    s_waitcnt vmcnt(0)
    ds_read_b64_tr_b16 v[248:249], v11 offset:0
    ds_read_b64_tr_b16 v[250:251], v11 offset:512
    ds_read_b64_tr_b16 v[252:253], v12 offset:0
    ds_read_b64_tr_b16 v[254:255], v12 offset:512
L_at_w2end_105:
    v_and_b32 v24, 7, v0
    s_lshl_b32 s52, s46, 5
    s_add_u32 s52, s52, s48
    s_add_u32 s52, s52, 479744
    v_lshl_add_u32 v2, v24, 2, s52
    v_lshrrev_b32 v25, 5, v0
    v_xor_b32 v25, v25, v24
    v_lshlrev_b32 v25, 4, v25
    v_and_b32 v24, 31, v0
    v_lshl_add_u32 v25, v24, 8, v25
    v_add_u32 v4, s69, v25
    v_xor_b32 v5, 32, v4
    v_xor_b32 v6, 64, v4
    v_xor_b32 v7, 96, v4
    s_lshl_b32 s53, s46, 13
    s_add_u32 s53, s53, 126976
    s_sub_u32 s53, s53, s69
    s_mul_i32 s58, s46, 22528
    s_add_u32 s58, s58, s48
    s_add_u32 s58, s58, 131072
    s_waitcnt lgkmcnt(0)
    buffer_load_dword v3, v2, s[24:27], 0 offen sc1
    s_mov_b32 s68, 0
    s_waitcnt vmcnt(0)
L_poll106:
    v_cmp_ne_u32 s[60:61], s49, v3
    s_nop 0
    s_cmp_lg_u64 s[60:61], 0
    s_cbranch_scc0 L_pdone107
    buffer_load_dword v3, v2, s[24:27], 0 offen sc1
    s_add_u32 s68, s68, 1
    s_cmp_lt_u32 s68, 200000
    s_waitcnt vmcnt(0)
    s_cbranch_scc1 L_poll106
L_pdone107:
L_at_pollD_108:
    s_add_u32 s52, s58, 0
    buffer_load_dwordx4 v[40:43], v1, s[24:27], s52 offen offset:0 sc1
    buffer_load_dwordx4 v[44:47], v1, s[24:27], s52 offen offset:1024 sc1
    buffer_load_dwordx4 v[48:51], v1, s[24:27], s52 offen offset:2048 sc1
    buffer_load_dwordx4 v[52:55], v1, s[24:27], s52 offen offset:3072 sc1
    s_add_u32 s52, s58, 4096
    buffer_load_dwordx4 v[56:59], v1, s[24:27], s52 offen offset:0 sc1
    buffer_load_dwordx4 v[60:63], v1, s[24:27], s52 offen offset:1024 sc1
    buffer_load_dwordx4 v[64:67], v1, s[24:27], s52 offen offset:2048 sc1
    buffer_load_dwordx4 v[68:71], v1, s[24:27], s52 offen offset:3072 sc1
    s_add_u32 s52, s58, 8192
    buffer_load_dwordx4 v[72:75], v1, s[24:27], s52 offen offset:0 sc1
    buffer_load_dwordx4 v[76:79], v1, s[24:27], s52 offen offset:1024 sc1
    s_waitcnt vmcnt(9)
    v_mfma_f32_32x32x16_bf16 v[8:23], v[80:83], v[40:43], 0
    v_mfma_f32_32x32x16_bf16 v[24:39], v[84:87], v[40:43], 0
    s_waitcnt vmcnt(8)
    v_mfma_f32_32x32x16_bf16 v[8:23], v[88:91], v[44:47], v[8:23]
    buffer_load_dwordx4 v[40:43], v1, s[24:27], s52 offen offset:2048 sc1
    v_mfma_f32_32x32x16_bf16 v[24:39], v[92:95], v[44:47], v[24:39]
    s_waitcnt vmcnt(8)
    v_mfma_f32_32x32x16_bf16 v[8:23], v[96:99], v[48:51], v[8:23]
    buffer_load_dwordx4 v[44:47], v1, s[24:27], s52 offen offset:3072 sc1
    v_mfma_f32_32x32x16_bf16 v[24:39], v[100:103], v[48:51], v[24:39]
    s_waitcnt vmcnt(8)
    v_mfma_f32_32x32x16_bf16 v[8:23], v[104:107], v[52:55], v[8:23]
    s_add_u32 s52, s58, 12288
    buffer_load_dwordx4 v[48:51], v1, s[24:27], s52 offen offset:0 sc1
    v_mfma_f32_32x32x16_bf16 v[24:39], v[108:111], v[52:55], v[24:39]
    s_waitcnt vmcnt(8)
    v_mfma_f32_32x32x16_bf16 v[8:23], v[112:115], v[56:59], v[8:23]
    buffer_load_dwordx4 v[52:55], v1, s[24:27], s52 offen offset:1024 sc1
    v_mfma_f32_32x32x16_bf16 v[24:39], v[116:119], v[56:59], v[24:39]
    s_waitcnt vmcnt(8)
    v_mfma_f32_32x32x16_bf16 v[8:23], v[120:123], v[60:63], v[8:23]
    buffer_load_dwordx4 v[56:59], v1, s[24:27], s52 offen offset:2048 sc1
    v_mfma_f32_32x32x16_bf16 v[24:39], v[124:127], v[60:63], v[24:39]
    s_waitcnt vmcnt(8)
    v_mfma_f32_32x32x16_bf16 v[8:23], v[128:131], v[64:67], v[8:23]
    buffer_load_dwordx4 v[60:63], v1, s[24:27], s52 offen offset:3072 sc1
    v_mfma_f32_32x32x16_bf16 v[24:39], v[132:135], v[64:67], v[24:39]
    s_waitcnt vmcnt(8)
    v_mfma_f32_32x32x16_bf16 v[8:23], v[136:139], v[68:71], v[8:23]
    s_add_u32 s52, s58, 16384
    buffer_load_dwordx4 v[64:67], v1, s[24:27], s52 offen offset:0 sc1
    v_mfma_f32_32x32x16_bf16 v[24:39], v[140:143], v[68:71], v[24:39]
    buffer_load_dword v3, v2, s[24:27], 0 offen offset:128 sc1
    s_waitcnt vmcnt(9)
    v_mfma_f32_32x32x16_bf16 v[8:23], v[144:147], v[72:75], v[8:23]
    buffer_load_dwordx4 v[68:71], v1, s[24:27], s52 offen offset:1024 sc1
    v_mfma_f32_32x32x16_bf16 v[24:39], v[148:151], v[72:75], v[24:39]
    s_waitcnt vmcnt(9)
    v_mfma_f32_32x32x16_bf16 v[8:23], v[152:155], v[76:79], v[8:23]
    buffer_load_dwordx4 v[72:75], v1, s[24:27], s52 offen offset:2048 sc1
    v_mfma_f32_32x32x16_bf16 v[24:39], v[156:159], v[76:79], v[24:39]
    s_waitcnt vmcnt(9)
    v_mfma_f32_32x32x16_bf16 v[8:23], v[160:163], v[40:43], v[8:23]
    buffer_load_dwordx4 v[76:79], v1, s[24:27], s52 offen offset:3072 sc1
    v_mfma_f32_32x32x16_bf16 v[24:39], v[164:167], v[40:43], v[24:39]
    s_waitcnt vmcnt(9)
    v_mfma_f32_32x32x16_bf16 v[8:23], v[168:171], v[44:47], v[8:23]
    s_add_u32 s52, s58, 20480
    buffer_load_dwordx4 v[40:43], v1, s[24:27], s52 offen offset:0 sc1
    v_mfma_f32_32x32x16_bf16 v[24:39], v[172:175], v[44:47], v[24:39]
    s_waitcnt vmcnt(9)
    v_mfma_f32_32x32x16_bf16 v[8:23], v[176:179], v[48:51], v[8:23]
    buffer_load_dwordx4 v[44:47], v1, s[24:27], s52 offen offset:1024 sc1
    v_mfma_f32_32x32x16_bf16 v[24:39], v[180:183], v[48:51], v[24:39]
    s_waitcnt vmcnt(9)
    v_mfma_f32_32x32x16_bf16 v[8:23], v[184:187], v[52:55], v[8:23]
    v_mfma_f32_32x32x16_bf16 v[24:39], v[188:191], v[52:55], v[24:39]
    s_waitcnt vmcnt(8)
    v_mfma_f32_32x32x16_bf16 v[8:23], v[192:195], v[56:59], v[8:23]
    v_mfma_f32_32x32x16_bf16 v[24:39], v[196:199], v[56:59], v[24:39]
    s_waitcnt vmcnt(7)
    v_mfma_f32_32x32x16_bf16 v[8:23], v[200:203], v[60:63], v[8:23]
    v_mfma_f32_32x32x16_bf16 v[24:39], v[204:207], v[60:63], v[24:39]
    s_waitcnt vmcnt(6)
    v_mfma_f32_32x32x16_bf16 v[8:23], v[208:211], v[64:67], v[8:23]
    v_mfma_f32_32x32x16_bf16 v[24:39], v[212:215], v[64:67], v[24:39]
    s_mov_b32 s68, 0
    s_waitcnt vmcnt(5)
L_poll109:
    v_cmp_ne_u32 s[60:61], s49, v3
    s_nop 0
    s_cmp_lg_u64 s[60:61], 0
    s_cbranch_scc0 L_pdone110
    buffer_load_dword v3, v2, s[24:27], 0 offen offset:128 sc1
    s_add_u32 s68, s68, 1
    s_cmp_lt_u32 s68, 200000
    s_waitcnt vmcnt(0)
    s_cbranch_scc1 L_poll109
L_pdone110:
    s_setprio 1
L_at_pollD1_111:
    s_add_u32 s52, s58, 90112
    buffer_load_dwordx4 v[48:51], v1, s[24:27], s52 offen offset:0 sc1
    buffer_load_dwordx4 v[52:55], v1, s[24:27], s52 offen offset:1024 sc1
    buffer_load_dwordx4 v[56:59], v1, s[24:27], s52 offen offset:2048 sc1
    buffer_load_dwordx4 v[60:63], v1, s[24:27], s52 offen offset:3072 sc1
    s_waitcnt vmcnt(8)
    v_mfma_f32_32x32x16_bf16 v[8:23], v[216:219], v[68:71], v[8:23]
    s_add_u32 s52, s58, 94208
    buffer_load_dwordx4 v[64:67], v1, s[24:27], s52 offen offset:0 sc1
    v_mfma_f32_32x32x16_bf16 v[24:39], v[220:223], v[68:71], v[24:39]
    s_waitcnt vmcnt(8)
    v_mfma_f32_32x32x16_bf16 v[8:23], v[224:227], v[72:75], v[8:23]
    buffer_load_dwordx4 v[68:71], v1, s[24:27], s52 offen offset:1024 sc1
    v_mfma_f32_32x32x16_bf16 v[24:39], v[228:231], v[72:75], v[24:39]
    s_waitcnt vmcnt(8)
    v_mfma_f32_32x32x16_bf16 v[8:23], v[232:235], v[76:79], v[8:23]
    buffer_load_dwordx4 v[72:75], v1, s[24:27], s52 offen offset:2048 sc1
    v_mfma_f32_32x32x16_bf16 v[24:39], v[236:239], v[76:79], v[24:39]
    s_waitcnt vmcnt(8)
    v_mfma_f32_32x32x16_bf16 v[8:23], v[240:243], v[40:43], v[8:23]
    buffer_load_dwordx4 v[76:79], v1, s[24:27], s52 offen offset:3072 sc1
    v_mfma_f32_32x32x16_bf16 v[24:39], v[244:247], v[40:43], v[24:39]
    s_waitcnt vmcnt(8)
    v_mfma_f32_32x32x16_bf16 v[8:23], v[248:251], v[44:47], v[8:23]
    s_add_u32 s52, s58, 98304
    buffer_load_dwordx4 v[40:43], v1, s[24:27], s52 offen offset:0 sc1
    v_mfma_f32_32x32x16_bf16 v[24:39], v[252:255], v[44:47], v[24:39]
L_at_s5h0_112:
    s_nop 8
    ds_write_b128 v4, v[8:11] offset:0
    ds_write_b128 v5, v[12:15] offset:0
    ds_write_b128 v6, v[16:19] offset:0
    ds_write_b128 v7, v[20:23] offset:0
    ds_write_b128 v4, v[24:27] offset:128
    ds_write_b128 v5, v[28:31] offset:128
    ds_write_b128 v6, v[32:35] offset:128
    ds_write_b128 v7, v[36:39] offset:128
    buffer_load_dwordx4 v[44:47], v1, s[24:27], s52 offen offset:1024 sc1
    s_waitcnt vmcnt(9)
    v_mfma_f32_32x32x16_bf16 v[8:23], v[80:83], v[48:51], 0
    v_mfma_f32_32x32x16_bf16 v[24:39], v[84:87], v[48:51], 0
    s_waitcnt vmcnt(8)
    v_mfma_f32_32x32x16_bf16 v[8:23], v[88:91], v[52:55], v[8:23]
    buffer_load_dwordx4 v[48:51], v1, s[24:27], s52 offen offset:2048 sc1
    v_mfma_f32_32x32x16_bf16 v[24:39], v[92:95], v[52:55], v[24:39]
    v_add_u32 v4, s53, v4
    v_add_u32 v5, s53, v5
    v_add_u32 v6, s53, v6
    v_add_u32 v7, s53, v7
    s_waitcnt lgkmcnt(0)
    s_barrier
    s_waitcnt vmcnt(8)
    v_mfma_f32_32x32x16_bf16 v[8:23], v[96:99], v[56:59], v[8:23]
    buffer_load_dwordx4 v[52:55], v1, s[24:27], s52 offen offset:3072 sc1
    v_mfma_f32_32x32x16_bf16 v[24:39], v[100:103], v[56:59], v[24:39]
    s_waitcnt vmcnt(8)
    v_mfma_f32_32x32x16_bf16 v[8:23], v[104:107], v[60:63], v[8:23]
    s_add_u32 s52, s58, 102400
    buffer_load_dwordx4 v[56:59], v1, s[24:27], s52 offen offset:0 sc1
    v_mfma_f32_32x32x16_bf16 v[24:39], v[108:111], v[60:63], v[24:39]
    s_waitcnt vmcnt(8)
    v_mfma_f32_32x32x16_bf16 v[8:23], v[112:115], v[64:67], v[8:23]
    buffer_load_dwordx4 v[60:63], v1, s[24:27], s52 offen offset:1024 sc1
    v_mfma_f32_32x32x16_bf16 v[24:39], v[116:119], v[64:67], v[24:39]
    s_waitcnt vmcnt(8)
    v_mfma_f32_32x32x16_bf16 v[8:23], v[120:123], v[68:71], v[8:23]
    buffer_load_dwordx4 v[64:67], v1, s[24:27], s52 offen offset:2048 sc1
    v_mfma_f32_32x32x16_bf16 v[24:39], v[124:127], v[68:71], v[24:39]
    s_waitcnt vmcnt(8)
    v_mfma_f32_32x32x16_bf16 v[8:23], v[128:131], v[72:75], v[8:23]
    buffer_load_dwordx4 v[68:71], v1, s[24:27], s52 offen offset:3072 sc1
    v_mfma_f32_32x32x16_bf16 v[24:39], v[132:135], v[72:75], v[24:39]
    s_waitcnt vmcnt(8)
    v_mfma_f32_32x32x16_bf16 v[8:23], v[136:139], v[76:79], v[8:23]
    s_add_u32 s52, s58, 106496
    buffer_load_dwordx4 v[72:75], v1, s[24:27], s52 offen offset:0 sc1
    v_mfma_f32_32x32x16_bf16 v[24:39], v[140:143], v[76:79], v[24:39]
    s_waitcnt vmcnt(8)
    v_mfma_f32_32x32x16_bf16 v[8:23], v[144:147], v[40:43], v[8:23]
    buffer_load_dwordx4 v[76:79], v1, s[24:27], s52 offen offset:1024 sc1
    v_mfma_f32_32x32x16_bf16 v[24:39], v[148:151], v[40:43], v[24:39]
    s_waitcnt vmcnt(8)
    v_mfma_f32_32x32x16_bf16 v[8:23], v[152:155], v[44:47], v[8:23]
    buffer_load_dwordx4 v[40:43], v1, s[24:27], s52 offen offset:2048 sc1
    v_mfma_f32_32x32x16_bf16 v[24:39], v[156:159], v[44:47], v[24:39]
    s_waitcnt vmcnt(8)
    v_mfma_f32_32x32x16_bf16 v[8:23], v[160:163], v[48:51], v[8:23]
    buffer_load_dwordx4 v[44:47], v1, s[24:27], s52 offen offset:3072 sc1
    v_mfma_f32_32x32x16_bf16 v[24:39], v[164:167], v[48:51], v[24:39]
    s_waitcnt vmcnt(8)
    v_mfma_f32_32x32x16_bf16 v[8:23], v[168:171], v[52:55], v[8:23]
    s_add_u32 s52, s58, 110592
    buffer_load_dwordx4 v[48:51], v1, s[24:27], s52 offen offset:0 sc1
    v_mfma_f32_32x32x16_bf16 v[24:39], v[172:175], v[52:55], v[24:39]
    s_waitcnt vmcnt(8)
    v_mfma_f32_32x32x16_bf16 v[8:23], v[176:179], v[56:59], v[8:23]
    buffer_load_dwordx4 v[52:55], v1, s[24:27], s52 offen offset:1024 sc1
    v_mfma_f32_32x32x16_bf16 v[24:39], v[180:183], v[56:59], v[24:39]
    s_waitcnt vmcnt(8)
    v_mfma_f32_32x32x16_bf16 v[8:23], v[184:187], v[60:63], v[8:23]
    v_mfma_f32_32x32x16_bf16 v[24:39], v[188:191], v[60:63], v[24:39]
    s_waitcnt vmcnt(7)
    v_mfma_f32_32x32x16_bf16 v[8:23], v[192:195], v[64:67], v[8:23]
    v_mfma_f32_32x32x16_bf16 v[24:39], v[196:199], v[64:67], v[24:39]
    s_waitcnt vmcnt(6)
    v_mfma_f32_32x32x16_bf16 v[8:23], v[200:203], v[68:71], v[8:23]
    v_mfma_f32_32x32x16_bf16 v[24:39], v[204:207], v[68:71], v[24:39]
    s_waitcnt vmcnt(5)
    v_mfma_f32_32x32x16_bf16 v[8:23], v[208:211], v[72:75], v[8:23]
    v_mfma_f32_32x32x16_bf16 v[24:39], v[212:215], v[72:75], v[24:39]
    s_waitcnt vmcnt(4)
    v_mfma_f32_32x32x16_bf16 v[8:23], v[216:219], v[76:79], v[8:23]
    v_mfma_f32_32x32x16_bf16 v[24:39], v[220:223], v[76:79], v[24:39]
    s_waitcnt vmcnt(3)
    v_mfma_f32_32x32x16_bf16 v[8:23], v[224:227], v[40:43], v[8:23]
    v_mfma_f32_32x32x16_bf16 v[24:39], v[228:231], v[40:43], v[24:39]
    s_waitcnt vmcnt(2)
    v_mfma_f32_32x32x16_bf16 v[8:23], v[232:235], v[44:47], v[8:23]
    v_mfma_f32_32x32x16_bf16 v[24:39], v[236:239], v[44:47], v[24:39]
    s_waitcnt vmcnt(1)
    v_mfma_f32_32x32x16_bf16 v[8:23], v[240:243], v[48:51], v[8:23]
    v_mfma_f32_32x32x16_bf16 v[24:39], v[244:247], v[48:51], v[24:39]
    s_waitcnt vmcnt(0)
    v_mfma_f32_32x32x16_bf16 v[8:23], v[248:251], v[52:55], v[8:23]
    v_mfma_f32_32x32x16_bf16 v[24:39], v[252:255], v[52:55], v[24:39]
L_at_s5h1_113:
    s_nop 10
    ds_write_b128 v4, v[8:11] offset:0
    ds_write_b128 v5, v[12:15] offset:0
    ds_write_b128 v6, v[16:19] offset:0
    ds_write_b128 v7, v[20:23] offset:0
    ds_write_b128 v4, v[24:27] offset:128
    ds_write_b128 v5, v[28:31] offset:128
    ds_write_b128 v6, v[32:35] offset:128
    ds_write_b128 v7, v[36:39] offset:128
    s_waitcnt lgkmcnt(0)
    s_barrier
L_exit:
    s_endpgm
L_end:
    s_endpgm
.section .rodata,"a"
.p2align 6
.amdhsa_kernel sequential_preLN__sliding_block__mixer_channel_mlp__prompt_kernel
  .amdhsa_next_free_vgpr 256
  .amdhsa_next_free_sgpr 102
  .amdhsa_accum_offset 256
  .amdhsa_group_segment_fixed_size 0
  .amdhsa_kernarg_size 88
  .amdhsa_user_sgpr_count 2
  .amdhsa_user_sgpr_kernarg_segment_ptr 1
  .amdhsa_system_sgpr_workgroup_id_x 1
.end_amdhsa_kernel
```
